```python
import torch

def _softmax(x, axis=-1):
    return torch.softmax(x, dim=axis)
def _gelu(x):
    return torch.nn.functional.gelu(x, approximate="tanh")
def _silu(x):
    return torch.nn.functional.silu(x)
def _sigmoid(x):
    return torch.sigmoid(x)
def _layernorm(x, axis=-1, eps=1e-5):
    m = x.mean(dim=axis, keepdim=True)
    v = x.var(dim=axis, keepdim=True, unbiased=False)
    return (x - m) / torch.sqrt(v + eps)
def _scatter_add(tgt, idx, src, axis=0):
    return tgt.clone().index_add_(axis, idx, src)
def _segment_sum(src, seg, n):
    out = torch.zeros((n,) + src.shape[1:], dtype=src.dtype)
    return out.index_add_(0, seg, src)
def _pad(x, pw):
    flat = tuple(v for pair in reversed(pw) for v in pair)
    return torch.nn.functional.pad(x, flat)

kernel_name = 'standalone__softmax_full_mha__prompt'

def setup_inputs():

    _w = (lambda a: (lambda t: t.to(torch.bfloat16) if t.is_floating_point() else t)(torch.as_tensor(a)))
    B, S, D = 1, 2048, 1024
    return {
        "x": _w((lambda *s: torch.randn(*s, dtype=torch.bfloat16) * 0.2)(B, S, D)),
        "wqkv": _w((lambda *s: torch.randn(*s, dtype=torch.bfloat16) * 0.2)(D, 3 * D)),
        "wo": _w((lambda *s: torch.randn(*s, dtype=torch.bfloat16) * 0.05)(D, D)),
    }

def reference(x, wqkv, wo):
    B, S, D = x.shape
    H = 32; Dh = D // H
    qkv = (lambda x, *d: x.permute(*d))((x @ wqkv).reshape(B, S, 3, H, Dh), 2, 0, 3, 1, 4)
    q, k, v = qkv[0], qkv[1], qkv[2]
    scale = Dh ** -0.5
    scores = torch.einsum("bhqd,bhkd->bhqk", q, k) * scale
    p = _softmax(scores, axis=-1)
    o = torch.einsum("bhqk,bhkd->bhqd", p, v)
    return (lambda x, *d: x.permute(*d))(o, 0, 2, 1, 3).reshape(B, S, D) @ wo
```

```asm
; @launch grid=(256,1,1) block=(512,1,1) lds=163840
.amdgcn_target "amdgcn-amd-amdhsa--gfx950"
.text
.globl standalone__softmax_full_mha__prompt_kernel
.p2align 8
.type standalone__softmax_full_mha__prompt_kernel,@function
standalone__softmax_full_mha__prompt_kernel:
  s_cmp_ge_u32 s2, 256
  s_cbranch_scc1 standalone__softmax_full_mha__prompt_kernel_end
  s_load_dwordx4 s[4:7], s[0:1], 0
  s_load_dwordx4 s[44:47], s[0:1], 16
  s_load_dwordx4 s[8:11], s[0:1], 32
  s_getpc_b64 s[40:41]
standalone__softmax_full_mha__prompt_kernel_pc0:
  v_lshlrev_b32 v2, 7, v0
  v_min_u32 v2, standalone__softmax_full_mha__prompt_kernel_end-standalone__softmax_full_mha__prompt_kernel_pc0, v2
  global_load_dword v207, v2, s[40:41]
  s_and_b32 s36, s2, 7
  s_lshr_b32 s37, s2, 3
  s_and_b32 s16, s36, 1
  s_lshl_b32 s16, s16, 3
  s_and_b32 s17, s37, 7
  s_add_u32 s16, s16, s17
  s_lshr_b32 s17, s36, 1
  s_lshl_b32 s17, s17, 2
  s_lshr_b32 s37, s37, 3
  s_add_u32 s17, s17, s37
  s_and_b32 s50, s2, 7
  s_lshl_b32 s50, s50, 1
  s_bfe_u32 s36, s2, 0x10003
  s_add_u32 s50, s50, s36
  s_lshr_b32 s51, s2, 4
  v_lshrrev_b32 v1, 6, v0
  v_and_b32 v0, 63, v0
  s_nop 0
  v_readfirstlane_b32 s18, v1
  s_cmp_lt_u32 s18, 4
  s_cbranch_scc1 standalone__softmax_full_mha__prompt_kernel_compute
standalone__softmax_full_mha__prompt_kernel_loader:
  s_sub_u32 s40, s18, 4
  v_lshrrev_b32 v2, 3, v0
  v_and_b32 v3, 7, v0
  v_lshrrev_b32 v4, 1, v2
  v_add_u32 v5, 0, v4
  v_and_b32 v5, 7, v5
  v_xor_b32 v5, v5, v3
  v_lshlrev_b32 v5, 4, v5
  s_lshl_b32 s36, s40, 5
  s_add_u32 s36, s36, 0
  v_add_u32 v6, s36, v2
  v_lshl_add_u32 v8, v6, 11, v5
  v_add_u32 v5, 4, v4
  v_and_b32 v5, 7, v5
  v_xor_b32 v5, v5, v3
  v_lshlrev_b32 v5, 4, v5
  s_lshl_b32 s36, s40, 5
  s_add_u32 s36, s36, 8
  v_add_u32 v6, s36, v2
  v_lshl_add_u32 v9, v6, 11, v5
  v_add_u32 v5, 0, v4
  v_and_b32 v5, 7, v5
  v_xor_b32 v5, v5, v3
  v_lshlrev_b32 v5, 4, v5
  s_lshl_b32 s36, s40, 5
  s_add_u32 s36, s36, 16
  v_add_u32 v6, s36, v2
  v_lshl_add_u32 v10, v6, 11, v5
  v_add_u32 v5, 4, v4
  v_and_b32 v5, 7, v5
  v_xor_b32 v5, v5, v3
  v_lshlrev_b32 v5, 4, v5
  s_lshl_b32 s36, s40, 5
  s_add_u32 s36, s36, 24
  v_add_u32 v6, s36, v2
  v_lshl_add_u32 v11, v6, 11, v5
  v_and_b32 v5, 1, v4
  v_lshlrev_b32 v5, 2, v5
  v_xor_b32 v5, v5, v3
  s_mov_b32 s37, 6144
  v_xor_b32 v7, 0, v5
  v_lshlrev_b32 v7, 4, v7
  s_lshl_b32 s36, s40, 4
  s_add_u32 s36, s36, 0
  v_add_u32 v6, s36, v2
  v_mul_lo_u32 v6, v6, s37
  v_add_u32 v6, v6, v7
  v_add_u32 v12, 0, v6
  v_add_u32 v14, 2048, v6
  v_add_u32 v16, 4096, v6
  v_xor_b32 v7, 2, v5
  v_lshlrev_b32 v7, 4, v7
  s_lshl_b32 s36, s40, 4
  s_add_u32 s36, s36, 8
  v_add_u32 v6, s36, v2
  v_mul_lo_u32 v6, v6, s37
  v_add_u32 v6, v6, v7
  v_add_u32 v13, 0, v6
  v_add_u32 v15, 2048, v6
  v_add_u32 v17, 4096, v6
  s_lshl_b32 s41, s40, 12
  s_lshl_b32 s42, s40, 11
  s_add_u32 s42, s42, 16384
  s_and_b32 s43, s16, 7
  s_lshl_b32 s43, s43, 1
  s_and_b32 s36, s17, 3
  s_lshl_b32 s36, s36, 2
  s_add_u32 s43, s43, s36
  s_and_b32 s43, s43, 15
  s_mov_b32 s34, 0
  s_waitcnt lgkmcnt(0)
  s_lshl_b32 s36, s16, 18
  s_add_u32 s4, s4, s36
  s_addc_u32 s5, s5, 0
  s_mov_b32 s20, s4
  s_and_b32 s21, s5, 0xffff
  s_mov_b32 s22, 262144
  s_mov_b32 s23, 0x00020000
  s_lshl_b32 s36, s17, 7
  s_add_u32 s6, s6, s36
  s_addc_u32 s7, s7, 0
  s_mov_b32 s24, s6
  s_and_b32 s25, s7, 0xffff
  s_mov_b32 s26, 0
  s_mov_b32 s27, 0x00020000
  s_sub_u32 s26, 6291456, s36
  s_mov_b32 s28, s10
  s_and_b32 s29, s11, 0xffff
  s_mov_b32 s30, 18874368
  s_mov_b32 s31, 0x00020000
  s_mov_b32 s35, 0
standalone__softmax_full_mha__prompt_kernel_lloop:
  s_lshl_b32 s32, s43, 7
  s_mul_i32 s33, s43, 393216
  s_add_u32 s36, s34, s41
  s_add_u32 s37, s34, s42
  s_add_u32 m0, s36, 0
  s_nop 0
  buffer_load_dwordx4 v8, s[20:23], s32 offen lds
  s_add_u32 m0, s36, 1024
  s_nop 0
  buffer_load_dwordx4 v9, s[20:23], s32 offen lds
  s_add_u32 m0, s36, 2048
  s_nop 0
  buffer_load_dwordx4 v10, s[20:23], s32 offen lds
  s_add_u32 m0, s36, 3072
  s_nop 0
  buffer_load_dwordx4 v11, s[20:23], s32 offen lds
  s_add_u32 m0, s37, 0
  s_nop 0
  buffer_load_dwordx4 v12, s[24:27], s33 offen lds
  s_add_u32 m0, s37, 1024
  s_nop 0
  buffer_load_dwordx4 v13, s[24:27], s33 offen lds
  s_add_u32 m0, s37, 8192
  s_nop 0
  buffer_load_dwordx4 v14, s[24:27], s33 offen lds
  s_add_u32 m0, s37, 9216
  s_nop 0
  buffer_load_dwordx4 v15, s[24:27], s33 offen lds
  s_add_u32 m0, s37, 16384
  s_nop 0
  buffer_load_dwordx4 v16, s[24:27], s33 offen lds
  s_add_u32 m0, s37, 17408
  s_nop 0
  buffer_load_dwordx4 v17, s[24:27], s33 offen lds
  s_add_u32 s43, s43, 1
  s_and_b32 s43, s43, 15
  s_add_u32 s34, s34, 40960
  s_cmp_eq_u32 s34, 163840
  s_cselect_b32 s34, 0, s34
  s_add_u32 s35, s35, 1
  s_cmp_lt_u32 s35, 2
  s_cbranch_scc1 standalone__softmax_full_mha__prompt_kernel_lloop
  s_waitcnt vmcnt(10)
standalone__softmax_full_mha__prompt_kernel_lw20:
  s_waitcnt vmcnt(20)
  s_barrier
  s_cmp_lt_u32 s35, 16
  s_cbranch_scc1 standalone__softmax_full_mha__prompt_kernel_lloop
  s_waitcnt vmcnt(0)
  s_barrier
  v_lshlrev_b32 v1, 4, v0
  v_and_b32 v2, 3, v0
  v_cmp_gt_u32 vcc, 2, v2
  v_bfe_u32 v3, v0, 2, 1
  v_cmp_eq_u32 s[56:57], 0, v3
  s_nop 1
  s_and_b64 s[58:59], vcc, s[56:57]
  s_andn2_b64 s[56:57], vcc, s[56:57]
  v_mov_b32 v4, 0x3f803f80
  v_cndmask_b32 v200, 0, v4, s[58:59]
  v_cndmask_b32 v201, 0, v4, s[58:59]
  v_cndmask_b32 v202, 0, v4, s[56:57]
  v_cndmask_b32 v203, 0, v4, s[56:57]
  v_mov_b32 v204, 0x4444
  v_mov_b32 v4, 0xeeee
  v_cmp_eq_u32 vcc, 1, v2
  s_nop 1
  v_cndmask_b32 v204, v204, v4, vcc
  v_mov_b32 v104, 0
  v_mov_b32 v105, 0
  v_mov_b32 v106, 0
  v_mov_b32 v107, 0
  v_mov_b32 v108, 0
  v_mov_b32 v109, 0
  v_mov_b32 v110, 0
  v_mov_b32 v111, 0
  v_mov_b32 v112, 0
  v_mov_b32 v113, 0
  v_mov_b32 v114, 0
  v_mov_b32 v115, 0
  v_mov_b32 v116, 0
  v_mov_b32 v117, 0
  v_mov_b32 v118, 0
  v_mov_b32 v119, 0
  v_mov_b32 v120, 0
  v_mov_b32 v121, 0
  v_mov_b32 v122, 0
  v_mov_b32 v123, 0
  v_mov_b32 v124, 0
  v_mov_b32 v125, 0
  v_mov_b32 v126, 0
  v_mov_b32 v127, 0
  v_mov_b32 v128, 0
  v_mov_b32 v129, 0
  v_mov_b32 v130, 0
  v_mov_b32 v131, 0
  v_mov_b32 v132, 0
  v_mov_b32 v133, 0
  v_mov_b32 v134, 0
  v_mov_b32 v135, 0
  v_mov_b32 v136, 0
  v_mov_b32 v137, 0
  v_mov_b32 v138, 0
  v_mov_b32 v139, 0
  v_mov_b32 v140, 0
  v_mov_b32 v141, 0
  v_mov_b32 v142, 0
  v_mov_b32 v143, 0
  v_mov_b32 v144, 0
  v_mov_b32 v145, 0
  v_mov_b32 v146, 0
  v_mov_b32 v147, 0
  v_mov_b32 v148, 0
  v_mov_b32 v149, 0
  v_mov_b32 v150, 0
  v_mov_b32 v151, 0
  v_mov_b32 v152, 0
  v_mov_b32 v153, 0
  v_mov_b32 v154, 0
  v_mov_b32 v155, 0
  v_mov_b32 v156, 0
  v_mov_b32 v157, 0
  v_mov_b32 v158, 0
  v_mov_b32 v159, 0
  v_mov_b32 v160, 0
  v_mov_b32 v161, 0
  v_mov_b32 v162, 0
  v_mov_b32 v163, 0
  v_mov_b32 v164, 0
  v_mov_b32 v165, 0
  v_mov_b32 v166, 0
  v_mov_b32 v167, 0
  v_mov_b32 v168, 0
  v_mov_b32 v169, 0
  v_mov_b32 v170, 0
  v_mov_b32 v171, 0
  v_mov_b32 v172, 0
  v_mov_b32 v173, 0
  v_mov_b32 v174, 0
  v_mov_b32 v175, 0
  v_mov_b32 v176, 0
  v_mov_b32 v177, 0
  v_mov_b32 v178, 0
  v_mov_b32 v179, 0
  v_mov_b32 v180, 0
  v_mov_b32 v181, 0
  v_mov_b32 v182, 0
  v_mov_b32 v183, 0
  v_mov_b32 v184, 0
  v_mov_b32 v185, 0
  v_mov_b32 v186, 0
  v_mov_b32 v187, 0
  v_mov_b32 v188, 0
  v_mov_b32 v189, 0
  v_mov_b32 v190, 0
  v_mov_b32 v191, 0
  v_mov_b32 v192, 0
  v_mov_b32 v193, 0
  v_mov_b32 v194, 0
  v_mov_b32 v195, 0
  v_mov_b32 v196, 0
  v_mov_b32 v197, 0
  v_mov_b32 v198, 0
  v_mov_b32 v199, 0
  v_mov_b32 v56, 0
  v_mov_b32 v57, 0
  v_mov_b32 v58, 0
  v_mov_b32 v59, 0
  v_mov_b32 v60, 0
  v_mov_b32 v61, 0
  v_mov_b32 v62, 0
  v_mov_b32 v63, 0
  v_mov_b32 v64, 0
  v_mov_b32 v65, 0
  v_mov_b32 v66, 0
  v_mov_b32 v67, 0
  v_mov_b32 v68, 0
  v_mov_b32 v69, 0
  v_mov_b32 v70, 0
  v_mov_b32 v71, 0
  s_branch standalone__softmax_full_mha__prompt_kernel_join
standalone__softmax_full_mha__prompt_kernel_compute:
  s_waitcnt lgkmcnt(0)
  s_lshl_b32 s36, s16, 18
  s_add_u32 s4, s4, s36
  s_addc_u32 s5, s5, 0
  s_mov_b32 s20, s4
  s_and_b32 s21, s5, 0xffff
  s_mov_b32 s22, 262144
  s_mov_b32 s23, 0x00020000
  s_lshl_b32 s36, s17, 7
  s_add_u32 s6, s6, s36
  s_addc_u32 s7, s7, 0
  s_mov_b32 s24, s6
  s_and_b32 s25, s7, 0xffff
  s_mov_b32 s26, 0
  s_mov_b32 s27, 0x00020000
  s_sub_u32 s26, 6291456, s36
  s_mov_b32 s28, s10
  s_and_b32 s29, s11, 0xffff
  s_mov_b32 s30, 18874368
  s_mov_b32 s31, 0x00020000
  s_cmp_lg_u32 s2, 0
  s_cbranch_scc1 standalone__softmax_full_mha__prompt_kernel_nononce
  s_cmp_lg_u32 s18, 0
  s_cbranch_scc1 standalone__softmax_full_mha__prompt_kernel_nononce
  s_memrealtime s[54:55]
  s_waitcnt lgkmcnt(0)
  s_or_b32 s54, s54, 1
  v_mov_b32 v2, 0
  v_mov_b32 v3, s54
  s_mov_b64 exec, 1
  global_store_dword v2, v3, s[8:9] sc1
  s_mov_b64 exec, -1
standalone__softmax_full_mha__prompt_kernel_nononce:
  s_lshr_b32 s40, s18, 1
  s_and_b32 s41, s18, 1
  v_and_b32 v2, 15, v0
  v_lshrrev_b32 v3, 4, v0
  s_lshl_b32 s36, s41, 6
  v_add_u32 v5, s36, v2
  v_lshrrev_b32 v4, 1, v2
  v_xor_b32 v4, v4, v3
  v_lshlrev_b32 v4, 4, v4
  v_lshl_add_u32 v192, v5, 7, v4
  v_xor_b32 v193, 64, v192
  v_bfe_u32 v4, v0, 2, 2
  v_lshl_add_u32 v5, v3, 3, v4
  v_lshlrev_b32 v5, 7, v5
  v_lshrrev_b32 v6, 1, v4
  v_xor_b32 v6, s40, v6
  v_lshl_add_u32 v5, v6, 6, v5
  v_and_b32 v6, 1, v3
  v_lshl_add_u32 v5, v6, 5, v5
  v_and_b32 v6, 3, v0
  v_lshl_add_u32 v5, v6, 3, v5
  v_add_u32 v194, 16384, v5
  v_xor_b32 v195, 32, v194
  v_mov_b32 v197, 0
  v_mov_b32 v196, 0
  v_mov_b32 v16, 0
  v_mov_b32 v17, 0
  v_mov_b32 v18, 0
  v_mov_b32 v19, 0
  v_mov_b32 v20, 0
  v_mov_b32 v21, 0
  v_mov_b32 v22, 0
  v_mov_b32 v23, 0
  v_mov_b32 v24, 0
  v_mov_b32 v25, 0
  v_mov_b32 v26, 0
  v_mov_b32 v27, 0
  v_mov_b32 v28, 0
  v_mov_b32 v29, 0
  v_mov_b32 v30, 0
  v_mov_b32 v31, 0
  v_mov_b32 v32, 0
  v_mov_b32 v33, 0
  v_mov_b32 v34, 0
  v_mov_b32 v35, 0
  v_mov_b32 v36, 0
  v_mov_b32 v37, 0
  v_mov_b32 v38, 0
  v_mov_b32 v39, 0
  v_mov_b32 v40, 0
  v_mov_b32 v41, 0
  v_mov_b32 v42, 0
  v_mov_b32 v43, 0
  v_mov_b32 v44, 0
  v_mov_b32 v45, 0
  v_mov_b32 v46, 0
  v_mov_b32 v47, 0
  v_mov_b32 v48, 0
  v_mov_b32 v49, 0
  v_mov_b32 v50, 0
  v_mov_b32 v51, 0
  v_mov_b32 v52, 0
  v_mov_b32 v53, 0
  v_mov_b32 v54, 0
  v_mov_b32 v55, 0
  v_mov_b32 v56, 0
  v_mov_b32 v57, 0
  v_mov_b32 v58, 0
  v_mov_b32 v59, 0
  v_mov_b32 v60, 0
  v_mov_b32 v61, 0
  v_mov_b32 v62, 0
  v_mov_b32 v63, 0
  v_mov_b32 v64, 0
  v_mov_b32 v65, 0
  v_mov_b32 v66, 0
  v_mov_b32 v67, 0
  v_mov_b32 v68, 0
  v_mov_b32 v69, 0
  v_mov_b32 v70, 0
  v_mov_b32 v71, 0
  v_mov_b32 v72, 0
  v_mov_b32 v73, 0
  v_mov_b32 v74, 0
  v_mov_b32 v75, 0
  v_mov_b32 v76, 0
  v_mov_b32 v77, 0
  v_mov_b32 v78, 0
  v_mov_b32 v79, 0
  v_mov_b32 v80, 0
  v_mov_b32 v81, 0
  v_mov_b32 v82, 0
  v_mov_b32 v83, 0
  v_mov_b32 v84, 0
  v_mov_b32 v85, 0
  v_mov_b32 v86, 0
  v_mov_b32 v87, 0
  v_mov_b32 v88, 0
  v_mov_b32 v89, 0
  v_mov_b32 v90, 0
  v_mov_b32 v91, 0
  v_mov_b32 v92, 0
  v_mov_b32 v93, 0
  v_mov_b32 v94, 0
  v_mov_b32 v95, 0
  v_mov_b32 v96, 0
  v_mov_b32 v97, 0
  v_mov_b32 v98, 0
  v_mov_b32 v99, 0
  v_mov_b32 v100, 0
  v_mov_b32 v101, 0
  v_mov_b32 v102, 0
  v_mov_b32 v103, 0
  v_mov_b32 v104, 0
  v_mov_b32 v105, 0
  v_mov_b32 v106, 0
  v_mov_b32 v107, 0
  v_mov_b32 v108, 0
  v_mov_b32 v109, 0
  v_mov_b32 v110, 0
  v_mov_b32 v111, 0
  v_add_u32 v198, 81920, v192
  v_add_u32 v200, 81920, v194
  v_add_u32 v199, 81920, v193
  v_add_u32 v201, 81920, v195
  s_mov_b32 s35, 0
  s_barrier
  ds_read_b128 v[112:115], v192 offset:0
  ds_read_b128 v[116:119], v192 offset:2048
  ds_read_b128 v[120:123], v192 offset:4096
  ds_read_b128 v[124:127], v192 offset:6144
  ds_read_b64_tr_b16 v[128:129], v194 offset:0
  ds_read_b64_tr_b16 v[130:131], v194 offset:512
  ds_read_b64_tr_b16 v[132:133], v195 offset:0
  ds_read_b64_tr_b16 v[134:135], v195 offset:512
  ds_read_b64_tr_b16 v[136:137], v194 offset:8192
  ds_read_b64_tr_b16 v[138:139], v194 offset:8704
  ds_read_b64_tr_b16 v[140:141], v195 offset:8192
  ds_read_b64_tr_b16 v[142:143], v195 offset:8704
  ds_read_b64_tr_b16 v[144:145], v194 offset:16384
  ds_read_b64_tr_b16 v[146:147], v194 offset:16896
  ds_read_b64_tr_b16 v[148:149], v195 offset:16384
  ds_read_b64_tr_b16 v[150:151], v195 offset:16896
standalone__softmax_full_mha__prompt_kernel_cloop:
  s_waitcnt lgkmcnt(0)
  v_mfma_f32_16x16x32_bf16 v[16:19], v[128:131], v[112:115], v[16:19]
  ds_read_b128 v[152:155], v193 offset:0
  v_mfma_f32_16x16x32_bf16 v[20:23], v[132:135], v[112:115], v[20:23]
  ds_read_b128 v[156:159], v193 offset:2048
  v_mfma_f32_16x16x32_bf16 v[48:51], v[136:139], v[112:115], v[48:51]
  ds_read_b128 v[160:163], v193 offset:4096
  v_mfma_f32_16x16x32_bf16 v[52:55], v[140:143], v[112:115], v[52:55]
  ds_read_b128 v[164:167], v193 offset:6144
  v_mfma_f32_16x16x32_bf16 v[80:83], v[112:115], v[144:147], v[80:83]
  ds_read_b64_tr_b16 v[168:169], v194 offset:4096
  v_mfma_f32_16x16x32_bf16 v[84:87], v[112:115], v[148:151], v[84:87]
  ds_read_b64_tr_b16 v[170:171], v194 offset:4608
  v_mfma_f32_16x16x32_bf16 v[24:27], v[128:131], v[116:119], v[24:27]
  ds_read_b64_tr_b16 v[172:173], v195 offset:4096
  v_mfma_f32_16x16x32_bf16 v[28:31], v[132:135], v[116:119], v[28:31]
  ds_read_b64_tr_b16 v[174:175], v195 offset:4608
  v_mfma_f32_16x16x32_bf16 v[56:59], v[136:139], v[116:119], v[56:59]
  ds_read_b64_tr_b16 v[176:177], v194 offset:12288
  v_mfma_f32_16x16x32_bf16 v[60:63], v[140:143], v[116:119], v[60:63]
  ds_read_b64_tr_b16 v[178:179], v194 offset:12800
  v_mfma_f32_16x16x32_bf16 v[88:91], v[116:119], v[144:147], v[88:91]
  ds_read_b64_tr_b16 v[180:181], v195 offset:12288
  v_mfma_f32_16x16x32_bf16 v[92:95], v[116:119], v[148:151], v[92:95]
  ds_read_b64_tr_b16 v[182:183], v195 offset:12800
  v_mfma_f32_16x16x32_bf16 v[32:35], v[128:131], v[120:123], v[32:35]
  ds_read_b64_tr_b16 v[184:185], v194 offset:20480
  v_mfma_f32_16x16x32_bf16 v[36:39], v[132:135], v[120:123], v[36:39]
  ds_read_b64_tr_b16 v[186:187], v194 offset:20992
  v_mfma_f32_16x16x32_bf16 v[64:67], v[136:139], v[120:123], v[64:67]
  ds_read_b64_tr_b16 v[188:189], v195 offset:20480
  v_mfma_f32_16x16x32_bf16 v[68:71], v[140:143], v[120:123], v[68:71]
  ds_read_b64_tr_b16 v[190:191], v195 offset:20992
  v_mfma_f32_16x16x32_bf16 v[96:99], v[120:123], v[144:147], v[96:99]
  v_mfma_f32_16x16x32_bf16 v[100:103], v[120:123], v[148:151], v[100:103]
  v_mfma_f32_16x16x32_bf16 v[40:43], v[128:131], v[124:127], v[40:43]
  v_mfma_f32_16x16x32_bf16 v[44:47], v[132:135], v[124:127], v[44:47]
  v_mfma_f32_16x16x32_bf16 v[72:75], v[136:139], v[124:127], v[72:75]
  v_mfma_f32_16x16x32_bf16 v[76:79], v[140:143], v[124:127], v[76:79]
  v_mfma_f32_16x16x32_bf16 v[104:107], v[124:127], v[144:147], v[104:107]
  v_mfma_f32_16x16x32_bf16 v[108:111], v[124:127], v[148:151], v[108:111]
  s_waitcnt lgkmcnt(0)
  s_barrier
  v_mfma_f32_16x16x32_bf16 v[16:19], v[168:171], v[152:155], v[16:19]
  ds_read_b128 v[112:115], v192 offset:40960
  v_mfma_f32_16x16x32_bf16 v[20:23], v[172:175], v[152:155], v[20:23]
  ds_read_b128 v[116:119], v192 offset:43008
  v_mfma_f32_16x16x32_bf16 v[48:51], v[176:179], v[152:155], v[48:51]
  ds_read_b128 v[120:123], v192 offset:45056
  v_mfma_f32_16x16x32_bf16 v[52:55], v[180:183], v[152:155], v[52:55]
  ds_read_b128 v[124:127], v192 offset:47104
  v_mfma_f32_16x16x32_bf16 v[80:83], v[152:155], v[184:187], v[80:83]
  ds_read_b64_tr_b16 v[128:129], v194 offset:40960
  v_mfma_f32_16x16x32_bf16 v[84:87], v[152:155], v[188:191], v[84:87]
  ds_read_b64_tr_b16 v[130:131], v194 offset:41472
  v_mfma_f32_16x16x32_bf16 v[24:27], v[168:171], v[156:159], v[24:27]
  ds_read_b64_tr_b16 v[132:133], v195 offset:40960
  v_mfma_f32_16x16x32_bf16 v[28:31], v[172:175], v[156:159], v[28:31]
  ds_read_b64_tr_b16 v[134:135], v195 offset:41472
  v_mfma_f32_16x16x32_bf16 v[56:59], v[176:179], v[156:159], v[56:59]
  ds_read_b64_tr_b16 v[136:137], v194 offset:49152
  v_mfma_f32_16x16x32_bf16 v[60:63], v[180:183], v[156:159], v[60:63]
  ds_read_b64_tr_b16 v[138:139], v194 offset:49664
  v_mfma_f32_16x16x32_bf16 v[88:91], v[156:159], v[184:187], v[88:91]
  ds_read_b64_tr_b16 v[140:141], v195 offset:49152
  v_mfma_f32_16x16x32_bf16 v[92:95], v[156:159], v[188:191], v[92:95]
  ds_read_b64_tr_b16 v[142:143], v195 offset:49664
  v_mfma_f32_16x16x32_bf16 v[32:35], v[168:171], v[160:163], v[32:35]
  ds_read_b64_tr_b16 v[144:145], v194 offset:57344
  v_mfma_f32_16x16x32_bf16 v[36:39], v[172:175], v[160:163], v[36:39]
  ds_read_b64_tr_b16 v[146:147], v194 offset:57856
  v_mfma_f32_16x16x32_bf16 v[64:67], v[176:179], v[160:163], v[64:67]
  ds_read_b64_tr_b16 v[148:149], v195 offset:57344
  v_mfma_f32_16x16x32_bf16 v[68:71], v[180:183], v[160:163], v[68:71]
  ds_read_b64_tr_b16 v[150:151], v195 offset:57856
  v_mfma_f32_16x16x32_bf16 v[96:99], v[160:163], v[184:187], v[96:99]
  v_mfma_f32_16x16x32_bf16 v[100:103], v[160:163], v[188:191], v[100:103]
  v_mfma_f32_16x16x32_bf16 v[40:43], v[168:171], v[164:167], v[40:43]
  v_mfma_f32_16x16x32_bf16 v[44:47], v[172:175], v[164:167], v[44:47]
  v_mfma_f32_16x16x32_bf16 v[72:75], v[176:179], v[164:167], v[72:75]
  v_mfma_f32_16x16x32_bf16 v[76:79], v[180:183], v[164:167], v[76:79]
  v_mfma_f32_16x16x32_bf16 v[104:107], v[164:167], v[184:187], v[104:107]
  v_mfma_f32_16x16x32_bf16 v[108:111], v[164:167], v[188:191], v[108:111]
  s_waitcnt lgkmcnt(0)
  v_mfma_f32_16x16x32_bf16 v[16:19], v[128:131], v[112:115], v[16:19]
  ds_read_b128 v[152:155], v193 offset:40960
  v_mfma_f32_16x16x32_bf16 v[20:23], v[132:135], v[112:115], v[20:23]
  ds_read_b128 v[156:159], v193 offset:43008
  v_mfma_f32_16x16x32_bf16 v[48:51], v[136:139], v[112:115], v[48:51]
  ds_read_b128 v[160:163], v193 offset:45056
  v_mfma_f32_16x16x32_bf16 v[52:55], v[140:143], v[112:115], v[52:55]
  ds_read_b128 v[164:167], v193 offset:47104
  v_mfma_f32_16x16x32_bf16 v[80:83], v[112:115], v[144:147], v[80:83]
  ds_read_b64_tr_b16 v[168:169], v194 offset:45056
  v_mfma_f32_16x16x32_bf16 v[84:87], v[112:115], v[148:151], v[84:87]
  ds_read_b64_tr_b16 v[170:171], v194 offset:45568
  v_mfma_f32_16x16x32_bf16 v[24:27], v[128:131], v[116:119], v[24:27]
  ds_read_b64_tr_b16 v[172:173], v195 offset:45056
  v_mfma_f32_16x16x32_bf16 v[28:31], v[132:135], v[116:119], v[28:31]
  ds_read_b64_tr_b16 v[174:175], v195 offset:45568
  v_mfma_f32_16x16x32_bf16 v[56:59], v[136:139], v[116:119], v[56:59]
  ds_read_b64_tr_b16 v[176:177], v194 offset:53248
  v_mfma_f32_16x16x32_bf16 v[60:63], v[140:143], v[116:119], v[60:63]
  ds_read_b64_tr_b16 v[178:179], v194 offset:53760
  v_mfma_f32_16x16x32_bf16 v[88:91], v[116:119], v[144:147], v[88:91]
  ds_read_b64_tr_b16 v[180:181], v195 offset:53248
  v_mfma_f32_16x16x32_bf16 v[92:95], v[116:119], v[148:151], v[92:95]
  ds_read_b64_tr_b16 v[182:183], v195 offset:53760
  v_mfma_f32_16x16x32_bf16 v[32:35], v[128:131], v[120:123], v[32:35]
  ds_read_b64_tr_b16 v[184:185], v194 offset:61440
  v_mfma_f32_16x16x32_bf16 v[36:39], v[132:135], v[120:123], v[36:39]
  ds_read_b64_tr_b16 v[186:187], v194 offset:61952
  v_mfma_f32_16x16x32_bf16 v[64:67], v[136:139], v[120:123], v[64:67]
  ds_read_b64_tr_b16 v[188:189], v195 offset:61440
  v_mfma_f32_16x16x32_bf16 v[68:71], v[140:143], v[120:123], v[68:71]
  ds_read_b64_tr_b16 v[190:191], v195 offset:61952
  v_mfma_f32_16x16x32_bf16 v[96:99], v[120:123], v[144:147], v[96:99]
  v_mfma_f32_16x16x32_bf16 v[100:103], v[120:123], v[148:151], v[100:103]
  v_mfma_f32_16x16x32_bf16 v[40:43], v[128:131], v[124:127], v[40:43]
  v_mfma_f32_16x16x32_bf16 v[44:47], v[132:135], v[124:127], v[44:47]
  v_mfma_f32_16x16x32_bf16 v[72:75], v[136:139], v[124:127], v[72:75]
  v_mfma_f32_16x16x32_bf16 v[76:79], v[140:143], v[124:127], v[76:79]
  v_mfma_f32_16x16x32_bf16 v[104:107], v[124:127], v[144:147], v[104:107]
  v_mfma_f32_16x16x32_bf16 v[108:111], v[124:127], v[148:151], v[108:111]
  s_waitcnt lgkmcnt(0)
  s_barrier
  v_mfma_f32_16x16x32_bf16 v[16:19], v[168:171], v[152:155], v[16:19]
  ds_read_b128 v[112:115], v198 offset:0
  v_mfma_f32_16x16x32_bf16 v[20:23], v[172:175], v[152:155], v[20:23]
  ds_read_b128 v[116:119], v198 offset:2048
  v_mfma_f32_16x16x32_bf16 v[48:51], v[176:179], v[152:155], v[48:51]
  ds_read_b128 v[120:123], v198 offset:4096
  v_mfma_f32_16x16x32_bf16 v[52:55], v[180:183], v[152:155], v[52:55]
  ds_read_b128 v[124:127], v198 offset:6144
  v_mfma_f32_16x16x32_bf16 v[80:83], v[152:155], v[184:187], v[80:83]
  ds_read_b64_tr_b16 v[128:129], v200 offset:0
  v_mfma_f32_16x16x32_bf16 v[84:87], v[152:155], v[188:191], v[84:87]
  ds_read_b64_tr_b16 v[130:131], v200 offset:512
  v_mfma_f32_16x16x32_bf16 v[24:27], v[168:171], v[156:159], v[24:27]
  ds_read_b64_tr_b16 v[132:133], v201 offset:0
  v_mfma_f32_16x16x32_bf16 v[28:31], v[172:175], v[156:159], v[28:31]
  ds_read_b64_tr_b16 v[134:135], v201 offset:512
  v_mfma_f32_16x16x32_bf16 v[56:59], v[176:179], v[156:159], v[56:59]
  ds_read_b64_tr_b16 v[136:137], v200 offset:8192
  v_mfma_f32_16x16x32_bf16 v[60:63], v[180:183], v[156:159], v[60:63]
  ds_read_b64_tr_b16 v[138:139], v200 offset:8704
  v_mfma_f32_16x16x32_bf16 v[88:91], v[156:159], v[184:187], v[88:91]
  ds_read_b64_tr_b16 v[140:141], v201 offset:8192
  v_mfma_f32_16x16x32_bf16 v[92:95], v[156:159], v[188:191], v[92:95]
  ds_read_b64_tr_b16 v[142:143], v201 offset:8704
  v_mfma_f32_16x16x32_bf16 v[32:35], v[168:171], v[160:163], v[32:35]
  ds_read_b64_tr_b16 v[144:145], v200 offset:16384
  v_mfma_f32_16x16x32_bf16 v[36:39], v[172:175], v[160:163], v[36:39]
  ds_read_b64_tr_b16 v[146:147], v200 offset:16896
  v_mfma_f32_16x16x32_bf16 v[64:67], v[176:179], v[160:163], v[64:67]
  ds_read_b64_tr_b16 v[148:149], v201 offset:16384
  v_mfma_f32_16x16x32_bf16 v[68:71], v[180:183], v[160:163], v[68:71]
  ds_read_b64_tr_b16 v[150:151], v201 offset:16896
  v_mfma_f32_16x16x32_bf16 v[96:99], v[160:163], v[184:187], v[96:99]
  v_mfma_f32_16x16x32_bf16 v[100:103], v[160:163], v[188:191], v[100:103]
  v_mfma_f32_16x16x32_bf16 v[40:43], v[168:171], v[164:167], v[40:43]
  v_mfma_f32_16x16x32_bf16 v[44:47], v[172:175], v[164:167], v[44:47]
  v_mfma_f32_16x16x32_bf16 v[72:75], v[176:179], v[164:167], v[72:75]
  v_mfma_f32_16x16x32_bf16 v[76:79], v[180:183], v[164:167], v[76:79]
  v_mfma_f32_16x16x32_bf16 v[104:107], v[164:167], v[184:187], v[104:107]
  v_mfma_f32_16x16x32_bf16 v[108:111], v[164:167], v[188:191], v[108:111]
  s_waitcnt lgkmcnt(0)
  v_mfma_f32_16x16x32_bf16 v[16:19], v[128:131], v[112:115], v[16:19]
  ds_read_b128 v[152:155], v199 offset:0
  v_mfma_f32_16x16x32_bf16 v[20:23], v[132:135], v[112:115], v[20:23]
  ds_read_b128 v[156:159], v199 offset:2048
  v_mfma_f32_16x16x32_bf16 v[48:51], v[136:139], v[112:115], v[48:51]
  ds_read_b128 v[160:163], v199 offset:4096
  v_mfma_f32_16x16x32_bf16 v[52:55], v[140:143], v[112:115], v[52:55]
  ds_read_b128 v[164:167], v199 offset:6144
  v_mfma_f32_16x16x32_bf16 v[80:83], v[112:115], v[144:147], v[80:83]
  ds_read_b64_tr_b16 v[168:169], v200 offset:4096
  v_mfma_f32_16x16x32_bf16 v[84:87], v[112:115], v[148:151], v[84:87]
  ds_read_b64_tr_b16 v[170:171], v200 offset:4608
  v_mfma_f32_16x16x32_bf16 v[24:27], v[128:131], v[116:119], v[24:27]
  ds_read_b64_tr_b16 v[172:173], v201 offset:4096
  v_mfma_f32_16x16x32_bf16 v[28:31], v[132:135], v[116:119], v[28:31]
  ds_read_b64_tr_b16 v[174:175], v201 offset:4608
  v_mfma_f32_16x16x32_bf16 v[56:59], v[136:139], v[116:119], v[56:59]
  ds_read_b64_tr_b16 v[176:177], v200 offset:12288
  v_mfma_f32_16x16x32_bf16 v[60:63], v[140:143], v[116:119], v[60:63]
  ds_read_b64_tr_b16 v[178:179], v200 offset:12800
  v_mfma_f32_16x16x32_bf16 v[88:91], v[116:119], v[144:147], v[88:91]
  ds_read_b64_tr_b16 v[180:181], v201 offset:12288
  v_mfma_f32_16x16x32_bf16 v[92:95], v[116:119], v[148:151], v[92:95]
  ds_read_b64_tr_b16 v[182:183], v201 offset:12800
  v_mfma_f32_16x16x32_bf16 v[32:35], v[128:131], v[120:123], v[32:35]
  ds_read_b64_tr_b16 v[184:185], v200 offset:20480
  v_mfma_f32_16x16x32_bf16 v[36:39], v[132:135], v[120:123], v[36:39]
  ds_read_b64_tr_b16 v[186:187], v200 offset:20992
  v_mfma_f32_16x16x32_bf16 v[64:67], v[136:139], v[120:123], v[64:67]
  ds_read_b64_tr_b16 v[188:189], v201 offset:20480
  v_mfma_f32_16x16x32_bf16 v[68:71], v[140:143], v[120:123], v[68:71]
  ds_read_b64_tr_b16 v[190:191], v201 offset:20992
  v_mfma_f32_16x16x32_bf16 v[96:99], v[120:123], v[144:147], v[96:99]
  v_mfma_f32_16x16x32_bf16 v[100:103], v[120:123], v[148:151], v[100:103]
  v_mfma_f32_16x16x32_bf16 v[40:43], v[128:131], v[124:127], v[40:43]
  v_mfma_f32_16x16x32_bf16 v[44:47], v[132:135], v[124:127], v[44:47]
  v_mfma_f32_16x16x32_bf16 v[72:75], v[136:139], v[124:127], v[72:75]
  v_mfma_f32_16x16x32_bf16 v[76:79], v[140:143], v[124:127], v[76:79]
  v_mfma_f32_16x16x32_bf16 v[104:107], v[124:127], v[144:147], v[104:107]
  v_mfma_f32_16x16x32_bf16 v[108:111], v[124:127], v[148:151], v[108:111]
  s_waitcnt lgkmcnt(0)
  s_barrier
  v_mfma_f32_16x16x32_bf16 v[16:19], v[168:171], v[152:155], v[16:19]
  ds_read_b128 v[112:115], v198 offset:40960
  v_mfma_f32_16x16x32_bf16 v[20:23], v[172:175], v[152:155], v[20:23]
  ds_read_b128 v[116:119], v198 offset:43008
  v_mfma_f32_16x16x32_bf16 v[48:51], v[176:179], v[152:155], v[48:51]
  ds_read_b128 v[120:123], v198 offset:45056
  v_mfma_f32_16x16x32_bf16 v[52:55], v[180:183], v[152:155], v[52:55]
  ds_read_b128 v[124:127], v198 offset:47104
  v_mfma_f32_16x16x32_bf16 v[80:83], v[152:155], v[184:187], v[80:83]
  ds_read_b64_tr_b16 v[128:129], v200 offset:40960
  v_mfma_f32_16x16x32_bf16 v[84:87], v[152:155], v[188:191], v[84:87]
  ds_read_b64_tr_b16 v[130:131], v200 offset:41472
  v_mfma_f32_16x16x32_bf16 v[24:27], v[168:171], v[156:159], v[24:27]
  ds_read_b64_tr_b16 v[132:133], v201 offset:40960
  v_mfma_f32_16x16x32_bf16 v[28:31], v[172:175], v[156:159], v[28:31]
  ds_read_b64_tr_b16 v[134:135], v201 offset:41472
  v_mfma_f32_16x16x32_bf16 v[56:59], v[176:179], v[156:159], v[56:59]
  ds_read_b64_tr_b16 v[136:137], v200 offset:49152
  v_mfma_f32_16x16x32_bf16 v[60:63], v[180:183], v[156:159], v[60:63]
  ds_read_b64_tr_b16 v[138:139], v200 offset:49664
  v_mfma_f32_16x16x32_bf16 v[88:91], v[156:159], v[184:187], v[88:91]
  ds_read_b64_tr_b16 v[140:141], v201 offset:49152
  v_mfma_f32_16x16x32_bf16 v[92:95], v[156:159], v[188:191], v[92:95]
  ds_read_b64_tr_b16 v[142:143], v201 offset:49664
  v_mfma_f32_16x16x32_bf16 v[32:35], v[168:171], v[160:163], v[32:35]
  ds_read_b64_tr_b16 v[144:145], v200 offset:57344
  v_mfma_f32_16x16x32_bf16 v[36:39], v[172:175], v[160:163], v[36:39]
  ds_read_b64_tr_b16 v[146:147], v200 offset:57856
  v_mfma_f32_16x16x32_bf16 v[64:67], v[176:179], v[160:163], v[64:67]
  ds_read_b64_tr_b16 v[148:149], v201 offset:57344
  v_mfma_f32_16x16x32_bf16 v[68:71], v[180:183], v[160:163], v[68:71]
  ds_read_b64_tr_b16 v[150:151], v201 offset:57856
  v_mfma_f32_16x16x32_bf16 v[96:99], v[160:163], v[184:187], v[96:99]
  v_mfma_f32_16x16x32_bf16 v[100:103], v[160:163], v[188:191], v[100:103]
  v_mfma_f32_16x16x32_bf16 v[40:43], v[168:171], v[164:167], v[40:43]
  v_mfma_f32_16x16x32_bf16 v[44:47], v[172:175], v[164:167], v[44:47]
  v_mfma_f32_16x16x32_bf16 v[72:75], v[176:179], v[164:167], v[72:75]
  v_mfma_f32_16x16x32_bf16 v[76:79], v[180:183], v[164:167], v[76:79]
  v_mfma_f32_16x16x32_bf16 v[104:107], v[164:167], v[184:187], v[104:107]
  v_mfma_f32_16x16x32_bf16 v[108:111], v[164:167], v[188:191], v[108:111]
  s_waitcnt lgkmcnt(0)
  v_mfma_f32_16x16x32_bf16 v[16:19], v[128:131], v[112:115], v[16:19]
  ds_read_b128 v[152:155], v199 offset:40960
  v_mfma_f32_16x16x32_bf16 v[20:23], v[132:135], v[112:115], v[20:23]
  ds_read_b128 v[156:159], v199 offset:43008
  v_mfma_f32_16x16x32_bf16 v[48:51], v[136:139], v[112:115], v[48:51]
  ds_read_b128 v[160:163], v199 offset:45056
  v_mfma_f32_16x16x32_bf16 v[52:55], v[140:143], v[112:115], v[52:55]
  ds_read_b128 v[164:167], v199 offset:47104
  v_mfma_f32_16x16x32_bf16 v[80:83], v[112:115], v[144:147], v[80:83]
  ds_read_b64_tr_b16 v[168:169], v200 offset:45056
  v_mfma_f32_16x16x32_bf16 v[84:87], v[112:115], v[148:151], v[84:87]
  ds_read_b64_tr_b16 v[170:171], v200 offset:45568
  v_mfma_f32_16x16x32_bf16 v[24:27], v[128:131], v[116:119], v[24:27]
  ds_read_b64_tr_b16 v[172:173], v201 offset:45056
  v_mfma_f32_16x16x32_bf16 v[28:31], v[132:135], v[116:119], v[28:31]
  ds_read_b64_tr_b16 v[174:175], v201 offset:45568
  v_mfma_f32_16x16x32_bf16 v[56:59], v[136:139], v[116:119], v[56:59]
  ds_read_b64_tr_b16 v[176:177], v200 offset:53248
  v_mfma_f32_16x16x32_bf16 v[60:63], v[140:143], v[116:119], v[60:63]
  ds_read_b64_tr_b16 v[178:179], v200 offset:53760
  v_mfma_f32_16x16x32_bf16 v[88:91], v[116:119], v[144:147], v[88:91]
  ds_read_b64_tr_b16 v[180:181], v201 offset:53248
  v_mfma_f32_16x16x32_bf16 v[92:95], v[116:119], v[148:151], v[92:95]
  ds_read_b64_tr_b16 v[182:183], v201 offset:53760
  v_mfma_f32_16x16x32_bf16 v[32:35], v[128:131], v[120:123], v[32:35]
  ds_read_b64_tr_b16 v[184:185], v200 offset:61440
  v_mfma_f32_16x16x32_bf16 v[36:39], v[132:135], v[120:123], v[36:39]
  ds_read_b64_tr_b16 v[186:187], v200 offset:61952
  v_mfma_f32_16x16x32_bf16 v[64:67], v[136:139], v[120:123], v[64:67]
  ds_read_b64_tr_b16 v[188:189], v201 offset:61440
  v_mfma_f32_16x16x32_bf16 v[68:71], v[140:143], v[120:123], v[68:71]
  ds_read_b64_tr_b16 v[190:191], v201 offset:61952
  v_mfma_f32_16x16x32_bf16 v[96:99], v[120:123], v[144:147], v[96:99]
  v_mfma_f32_16x16x32_bf16 v[100:103], v[120:123], v[148:151], v[100:103]
  v_mfma_f32_16x16x32_bf16 v[40:43], v[128:131], v[124:127], v[40:43]
  v_mfma_f32_16x16x32_bf16 v[44:47], v[132:135], v[124:127], v[44:47]
  v_mfma_f32_16x16x32_bf16 v[72:75], v[136:139], v[124:127], v[72:75]
  v_mfma_f32_16x16x32_bf16 v[76:79], v[140:143], v[124:127], v[76:79]
  v_mfma_f32_16x16x32_bf16 v[104:107], v[124:127], v[144:147], v[104:107]
  v_mfma_f32_16x16x32_bf16 v[108:111], v[124:127], v[148:151], v[108:111]
  s_waitcnt lgkmcnt(0)
  s_barrier
  v_mfma_f32_16x16x32_bf16 v[16:19], v[168:171], v[152:155], v[16:19]
  ds_read_b128 v[112:115], v192 offset:0
  v_mfma_f32_16x16x32_bf16 v[20:23], v[172:175], v[152:155], v[20:23]
  ds_read_b128 v[116:119], v192 offset:2048
  v_mfma_f32_16x16x32_bf16 v[48:51], v[176:179], v[152:155], v[48:51]
  ds_read_b128 v[120:123], v192 offset:4096
  v_mfma_f32_16x16x32_bf16 v[52:55], v[180:183], v[152:155], v[52:55]
  ds_read_b128 v[124:127], v192 offset:6144
  v_mfma_f32_16x16x32_bf16 v[80:83], v[152:155], v[184:187], v[80:83]
  ds_read_b64_tr_b16 v[128:129], v194 offset:0
  v_mfma_f32_16x16x32_bf16 v[84:87], v[152:155], v[188:191], v[84:87]
  ds_read_b64_tr_b16 v[130:131], v194 offset:512
  v_mfma_f32_16x16x32_bf16 v[24:27], v[168:171], v[156:159], v[24:27]
  ds_read_b64_tr_b16 v[132:133], v195 offset:0
  v_mfma_f32_16x16x32_bf16 v[28:31], v[172:175], v[156:159], v[28:31]
  ds_read_b64_tr_b16 v[134:135], v195 offset:512
  v_mfma_f32_16x16x32_bf16 v[56:59], v[176:179], v[156:159], v[56:59]
  ds_read_b64_tr_b16 v[136:137], v194 offset:8192
  v_mfma_f32_16x16x32_bf16 v[60:63], v[180:183], v[156:159], v[60:63]
  ds_read_b64_tr_b16 v[138:139], v194 offset:8704
  v_mfma_f32_16x16x32_bf16 v[88:91], v[156:159], v[184:187], v[88:91]
  ds_read_b64_tr_b16 v[140:141], v195 offset:8192
  v_mfma_f32_16x16x32_bf16 v[92:95], v[156:159], v[188:191], v[92:95]
  ds_read_b64_tr_b16 v[142:143], v195 offset:8704
  v_mfma_f32_16x16x32_bf16 v[32:35], v[168:171], v[160:163], v[32:35]
  ds_read_b64_tr_b16 v[144:145], v194 offset:16384
  v_mfma_f32_16x16x32_bf16 v[36:39], v[172:175], v[160:163], v[36:39]
  ds_read_b64_tr_b16 v[146:147], v194 offset:16896
  v_mfma_f32_16x16x32_bf16 v[64:67], v[176:179], v[160:163], v[64:67]
  ds_read_b64_tr_b16 v[148:149], v195 offset:16384
  v_mfma_f32_16x16x32_bf16 v[68:71], v[180:183], v[160:163], v[68:71]
  ds_read_b64_tr_b16 v[150:151], v195 offset:16896
  v_mfma_f32_16x16x32_bf16 v[96:99], v[160:163], v[184:187], v[96:99]
  v_mfma_f32_16x16x32_bf16 v[100:103], v[160:163], v[188:191], v[100:103]
  v_mfma_f32_16x16x32_bf16 v[40:43], v[168:171], v[164:167], v[40:43]
  v_mfma_f32_16x16x32_bf16 v[44:47], v[172:175], v[164:167], v[44:47]
  v_mfma_f32_16x16x32_bf16 v[72:75], v[176:179], v[164:167], v[72:75]
  v_mfma_f32_16x16x32_bf16 v[76:79], v[180:183], v[164:167], v[76:79]
  v_mfma_f32_16x16x32_bf16 v[104:107], v[164:167], v[184:187], v[104:107]
  v_mfma_f32_16x16x32_bf16 v[108:111], v[164:167], v[188:191], v[108:111]
  s_add_u32 s35, s35, 1
  s_cmp_lt_u32 s35, 3
  s_cbranch_scc1 standalone__softmax_full_mha__prompt_kernel_cloop
  global_load_dword v196, v197, s[8:9] sc1
  s_waitcnt lgkmcnt(0)
  v_mfma_f32_16x16x32_bf16 v[16:19], v[128:131], v[112:115], v[16:19]
  ds_read_b128 v[152:155], v193 offset:0
  v_mfma_f32_16x16x32_bf16 v[20:23], v[132:135], v[112:115], v[20:23]
  ds_read_b128 v[156:159], v193 offset:2048
  v_mfma_f32_16x16x32_bf16 v[48:51], v[136:139], v[112:115], v[48:51]
  ds_read_b128 v[160:163], v193 offset:4096
  v_mfma_f32_16x16x32_bf16 v[52:55], v[140:143], v[112:115], v[52:55]
  ds_read_b128 v[164:167], v193 offset:6144
  v_mfma_f32_16x16x32_bf16 v[80:83], v[112:115], v[144:147], v[80:83]
  ds_read_b64_tr_b16 v[168:169], v194 offset:4096
  v_mfma_f32_16x16x32_bf16 v[84:87], v[112:115], v[148:151], v[84:87]
  ds_read_b64_tr_b16 v[170:171], v194 offset:4608
  v_mfma_f32_16x16x32_bf16 v[24:27], v[128:131], v[116:119], v[24:27]
  ds_read_b64_tr_b16 v[172:173], v195 offset:4096
  v_mfma_f32_16x16x32_bf16 v[28:31], v[132:135], v[116:119], v[28:31]
  ds_read_b64_tr_b16 v[174:175], v195 offset:4608
  v_mfma_f32_16x16x32_bf16 v[56:59], v[136:139], v[116:119], v[56:59]
  ds_read_b64_tr_b16 v[176:177], v194 offset:12288
  v_mfma_f32_16x16x32_bf16 v[60:63], v[140:143], v[116:119], v[60:63]
  ds_read_b64_tr_b16 v[178:179], v194 offset:12800
  v_mfma_f32_16x16x32_bf16 v[88:91], v[116:119], v[144:147], v[88:91]
  ds_read_b64_tr_b16 v[180:181], v195 offset:12288
  v_mfma_f32_16x16x32_bf16 v[92:95], v[116:119], v[148:151], v[92:95]
  ds_read_b64_tr_b16 v[182:183], v195 offset:12800
  v_mfma_f32_16x16x32_bf16 v[32:35], v[128:131], v[120:123], v[32:35]
  ds_read_b64_tr_b16 v[184:185], v194 offset:20480
  v_mfma_f32_16x16x32_bf16 v[36:39], v[132:135], v[120:123], v[36:39]
  ds_read_b64_tr_b16 v[186:187], v194 offset:20992
  v_mfma_f32_16x16x32_bf16 v[64:67], v[136:139], v[120:123], v[64:67]
  ds_read_b64_tr_b16 v[188:189], v195 offset:20480
  v_mfma_f32_16x16x32_bf16 v[68:71], v[140:143], v[120:123], v[68:71]
  ds_read_b64_tr_b16 v[190:191], v195 offset:20992
  v_mfma_f32_16x16x32_bf16 v[96:99], v[120:123], v[144:147], v[96:99]
  v_mfma_f32_16x16x32_bf16 v[100:103], v[120:123], v[148:151], v[100:103]
  v_mfma_f32_16x16x32_bf16 v[40:43], v[128:131], v[124:127], v[40:43]
  v_mfma_f32_16x16x32_bf16 v[44:47], v[132:135], v[124:127], v[44:47]
  v_mfma_f32_16x16x32_bf16 v[72:75], v[136:139], v[124:127], v[72:75]
  v_mfma_f32_16x16x32_bf16 v[76:79], v[140:143], v[124:127], v[76:79]
  v_mfma_f32_16x16x32_bf16 v[104:107], v[124:127], v[144:147], v[104:107]
  v_mfma_f32_16x16x32_bf16 v[108:111], v[124:127], v[148:151], v[108:111]
  s_waitcnt lgkmcnt(0)
  s_barrier
  v_mfma_f32_16x16x32_bf16 v[16:19], v[168:171], v[152:155], v[16:19]
  ds_read_b128 v[112:115], v192 offset:40960
  v_mfma_f32_16x16x32_bf16 v[20:23], v[172:175], v[152:155], v[20:23]
  ds_read_b128 v[116:119], v192 offset:43008
  v_mfma_f32_16x16x32_bf16 v[48:51], v[176:179], v[152:155], v[48:51]
  ds_read_b128 v[120:123], v192 offset:45056
  v_mfma_f32_16x16x32_bf16 v[52:55], v[180:183], v[152:155], v[52:55]
  ds_read_b128 v[124:127], v192 offset:47104
  v_mfma_f32_16x16x32_bf16 v[80:83], v[152:155], v[184:187], v[80:83]
  ds_read_b64_tr_b16 v[128:129], v194 offset:40960
  v_mfma_f32_16x16x32_bf16 v[84:87], v[152:155], v[188:191], v[84:87]
  ds_read_b64_tr_b16 v[130:131], v194 offset:41472
  v_mfma_f32_16x16x32_bf16 v[24:27], v[168:171], v[156:159], v[24:27]
  ds_read_b64_tr_b16 v[132:133], v195 offset:40960
  v_mfma_f32_16x16x32_bf16 v[28:31], v[172:175], v[156:159], v[28:31]
  ds_read_b64_tr_b16 v[134:135], v195 offset:41472
  v_mfma_f32_16x16x32_bf16 v[56:59], v[176:179], v[156:159], v[56:59]
  ds_read_b64_tr_b16 v[136:137], v194 offset:49152
  v_mfma_f32_16x16x32_bf16 v[60:63], v[180:183], v[156:159], v[60:63]
  ds_read_b64_tr_b16 v[138:139], v194 offset:49664
  v_mfma_f32_16x16x32_bf16 v[88:91], v[156:159], v[184:187], v[88:91]
  ds_read_b64_tr_b16 v[140:141], v195 offset:49152
  v_mfma_f32_16x16x32_bf16 v[92:95], v[156:159], v[188:191], v[92:95]
  ds_read_b64_tr_b16 v[142:143], v195 offset:49664
  v_mfma_f32_16x16x32_bf16 v[32:35], v[168:171], v[160:163], v[32:35]
  ds_read_b64_tr_b16 v[144:145], v194 offset:57344
  v_mfma_f32_16x16x32_bf16 v[36:39], v[172:175], v[160:163], v[36:39]
  ds_read_b64_tr_b16 v[146:147], v194 offset:57856
  v_mfma_f32_16x16x32_bf16 v[64:67], v[176:179], v[160:163], v[64:67]
  ds_read_b64_tr_b16 v[148:149], v195 offset:57344
  v_mfma_f32_16x16x32_bf16 v[68:71], v[180:183], v[160:163], v[68:71]
  ds_read_b64_tr_b16 v[150:151], v195 offset:57856
  v_mfma_f32_16x16x32_bf16 v[96:99], v[160:163], v[184:187], v[96:99]
  v_mfma_f32_16x16x32_bf16 v[100:103], v[160:163], v[188:191], v[100:103]
  v_mfma_f32_16x16x32_bf16 v[40:43], v[168:171], v[164:167], v[40:43]
  v_mfma_f32_16x16x32_bf16 v[44:47], v[172:175], v[164:167], v[44:47]
  v_mfma_f32_16x16x32_bf16 v[72:75], v[176:179], v[164:167], v[72:75]
  v_mfma_f32_16x16x32_bf16 v[76:79], v[180:183], v[164:167], v[76:79]
  v_mfma_f32_16x16x32_bf16 v[104:107], v[164:167], v[184:187], v[104:107]
  v_mfma_f32_16x16x32_bf16 v[108:111], v[164:167], v[188:191], v[108:111]
  s_waitcnt lgkmcnt(0)
  v_mfma_f32_16x16x32_bf16 v[16:19], v[128:131], v[112:115], v[16:19]
  ds_read_b128 v[152:155], v193 offset:40960
  v_mfma_f32_16x16x32_bf16 v[20:23], v[132:135], v[112:115], v[20:23]
  ds_read_b128 v[156:159], v193 offset:43008
  v_mfma_f32_16x16x32_bf16 v[48:51], v[136:139], v[112:115], v[48:51]
  ds_read_b128 v[160:163], v193 offset:45056
  v_mfma_f32_16x16x32_bf16 v[52:55], v[140:143], v[112:115], v[52:55]
  ds_read_b128 v[164:167], v193 offset:47104
  v_mfma_f32_16x16x32_bf16 v[80:83], v[112:115], v[144:147], v[80:83]
  ds_read_b64_tr_b16 v[168:169], v194 offset:45056
  v_mfma_f32_16x16x32_bf16 v[84:87], v[112:115], v[148:151], v[84:87]
  ds_read_b64_tr_b16 v[170:171], v194 offset:45568
  v_mfma_f32_16x16x32_bf16 v[24:27], v[128:131], v[116:119], v[24:27]
  ds_read_b64_tr_b16 v[172:173], v195 offset:45056
  v_mfma_f32_16x16x32_bf16 v[28:31], v[132:135], v[116:119], v[28:31]
  ds_read_b64_tr_b16 v[174:175], v195 offset:45568
  v_mfma_f32_16x16x32_bf16 v[56:59], v[136:139], v[116:119], v[56:59]
  ds_read_b64_tr_b16 v[176:177], v194 offset:53248
  v_mfma_f32_16x16x32_bf16 v[60:63], v[140:143], v[116:119], v[60:63]
  ds_read_b64_tr_b16 v[178:179], v194 offset:53760
  v_mfma_f32_16x16x32_bf16 v[88:91], v[116:119], v[144:147], v[88:91]
  ds_read_b64_tr_b16 v[180:181], v195 offset:53248
  v_mfma_f32_16x16x32_bf16 v[92:95], v[116:119], v[148:151], v[92:95]
  ds_read_b64_tr_b16 v[182:183], v195 offset:53760
  v_mfma_f32_16x16x32_bf16 v[32:35], v[128:131], v[120:123], v[32:35]
  ds_read_b64_tr_b16 v[184:185], v194 offset:61440
  v_mfma_f32_16x16x32_bf16 v[36:39], v[132:135], v[120:123], v[36:39]
  ds_read_b64_tr_b16 v[186:187], v194 offset:61952
  v_mfma_f32_16x16x32_bf16 v[64:67], v[136:139], v[120:123], v[64:67]
  ds_read_b64_tr_b16 v[188:189], v195 offset:61440
  v_mfma_f32_16x16x32_bf16 v[68:71], v[140:143], v[120:123], v[68:71]
  ds_read_b64_tr_b16 v[190:191], v195 offset:61952
  v_mfma_f32_16x16x32_bf16 v[96:99], v[120:123], v[144:147], v[96:99]
  v_mfma_f32_16x16x32_bf16 v[100:103], v[120:123], v[148:151], v[100:103]
  v_mfma_f32_16x16x32_bf16 v[40:43], v[128:131], v[124:127], v[40:43]
  v_mfma_f32_16x16x32_bf16 v[44:47], v[132:135], v[124:127], v[44:47]
  v_mfma_f32_16x16x32_bf16 v[72:75], v[136:139], v[124:127], v[72:75]
  v_mfma_f32_16x16x32_bf16 v[76:79], v[140:143], v[124:127], v[76:79]
  v_mfma_f32_16x16x32_bf16 v[104:107], v[124:127], v[144:147], v[104:107]
  v_mfma_f32_16x16x32_bf16 v[108:111], v[124:127], v[148:151], v[108:111]
  s_waitcnt lgkmcnt(0)
  s_barrier
  v_mfma_f32_16x16x32_bf16 v[16:19], v[168:171], v[152:155], v[16:19]
  ds_read_b128 v[112:115], v198 offset:0
  v_mfma_f32_16x16x32_bf16 v[20:23], v[172:175], v[152:155], v[20:23]
  ds_read_b128 v[116:119], v198 offset:2048
  v_mfma_f32_16x16x32_bf16 v[48:51], v[176:179], v[152:155], v[48:51]
  ds_read_b128 v[120:123], v198 offset:4096
  v_mfma_f32_16x16x32_bf16 v[52:55], v[180:183], v[152:155], v[52:55]
  ds_read_b128 v[124:127], v198 offset:6144
  v_mfma_f32_16x16x32_bf16 v[80:83], v[152:155], v[184:187], v[80:83]
  ds_read_b64_tr_b16 v[128:129], v200 offset:0
  v_mfma_f32_16x16x32_bf16 v[84:87], v[152:155], v[188:191], v[84:87]
  ds_read_b64_tr_b16 v[130:131], v200 offset:512
  v_mfma_f32_16x16x32_bf16 v[24:27], v[168:171], v[156:159], v[24:27]
  ds_read_b64_tr_b16 v[132:133], v201 offset:0
  v_mfma_f32_16x16x32_bf16 v[28:31], v[172:175], v[156:159], v[28:31]
  ds_read_b64_tr_b16 v[134:135], v201 offset:512
  v_mfma_f32_16x16x32_bf16 v[56:59], v[176:179], v[156:159], v[56:59]
  ds_read_b64_tr_b16 v[136:137], v200 offset:8192
  v_mfma_f32_16x16x32_bf16 v[60:63], v[180:183], v[156:159], v[60:63]
  ds_read_b64_tr_b16 v[138:139], v200 offset:8704
  v_mfma_f32_16x16x32_bf16 v[88:91], v[156:159], v[184:187], v[88:91]
  ds_read_b64_tr_b16 v[140:141], v201 offset:8192
  v_mfma_f32_16x16x32_bf16 v[92:95], v[156:159], v[188:191], v[92:95]
  ds_read_b64_tr_b16 v[142:143], v201 offset:8704
  v_mfma_f32_16x16x32_bf16 v[32:35], v[168:171], v[160:163], v[32:35]
  ds_read_b64_tr_b16 v[144:145], v200 offset:16384
  v_mfma_f32_16x16x32_bf16 v[36:39], v[172:175], v[160:163], v[36:39]
  ds_read_b64_tr_b16 v[146:147], v200 offset:16896
  v_mfma_f32_16x16x32_bf16 v[64:67], v[176:179], v[160:163], v[64:67]
  ds_read_b64_tr_b16 v[148:149], v201 offset:16384
  v_mfma_f32_16x16x32_bf16 v[68:71], v[180:183], v[160:163], v[68:71]
  ds_read_b64_tr_b16 v[150:151], v201 offset:16896
  v_mfma_f32_16x16x32_bf16 v[96:99], v[160:163], v[184:187], v[96:99]
  v_mfma_f32_16x16x32_bf16 v[100:103], v[160:163], v[188:191], v[100:103]
  v_mfma_f32_16x16x32_bf16 v[40:43], v[168:171], v[164:167], v[40:43]
  v_mfma_f32_16x16x32_bf16 v[44:47], v[172:175], v[164:167], v[44:47]
  v_mfma_f32_16x16x32_bf16 v[72:75], v[176:179], v[164:167], v[72:75]
  v_mfma_f32_16x16x32_bf16 v[76:79], v[180:183], v[164:167], v[76:79]
  v_mfma_f32_16x16x32_bf16 v[104:107], v[164:167], v[184:187], v[104:107]
  v_mfma_f32_16x16x32_bf16 v[108:111], v[164:167], v[188:191], v[108:111]
  s_waitcnt lgkmcnt(0)
  v_mfma_f32_16x16x32_bf16 v[16:19], v[128:131], v[112:115], v[16:19]
  ds_read_b128 v[152:155], v199 offset:0
  v_mfma_f32_16x16x32_bf16 v[20:23], v[132:135], v[112:115], v[20:23]
  ds_read_b128 v[156:159], v199 offset:2048
  v_mfma_f32_16x16x32_bf16 v[48:51], v[136:139], v[112:115], v[48:51]
  ds_read_b128 v[160:163], v199 offset:4096
  v_mfma_f32_16x16x32_bf16 v[52:55], v[140:143], v[112:115], v[52:55]
  ds_read_b128 v[164:167], v199 offset:6144
  v_mfma_f32_16x16x32_bf16 v[80:83], v[112:115], v[144:147], v[80:83]
  ds_read_b64_tr_b16 v[168:169], v200 offset:4096
  v_mfma_f32_16x16x32_bf16 v[84:87], v[112:115], v[148:151], v[84:87]
  ds_read_b64_tr_b16 v[170:171], v200 offset:4608
  v_mfma_f32_16x16x32_bf16 v[24:27], v[128:131], v[116:119], v[24:27]
  ds_read_b64_tr_b16 v[172:173], v201 offset:4096
  v_mfma_f32_16x16x32_bf16 v[28:31], v[132:135], v[116:119], v[28:31]
  ds_read_b64_tr_b16 v[174:175], v201 offset:4608
  v_mfma_f32_16x16x32_bf16 v[56:59], v[136:139], v[116:119], v[56:59]
  ds_read_b64_tr_b16 v[176:177], v200 offset:12288
  v_mfma_f32_16x16x32_bf16 v[60:63], v[140:143], v[116:119], v[60:63]
  ds_read_b64_tr_b16 v[178:179], v200 offset:12800
  v_mfma_f32_16x16x32_bf16 v[88:91], v[116:119], v[144:147], v[88:91]
  ds_read_b64_tr_b16 v[180:181], v201 offset:12288
  v_mfma_f32_16x16x32_bf16 v[92:95], v[116:119], v[148:151], v[92:95]
  ds_read_b64_tr_b16 v[182:183], v201 offset:12800
  v_mfma_f32_16x16x32_bf16 v[32:35], v[128:131], v[120:123], v[32:35]
  ds_read_b64_tr_b16 v[184:185], v200 offset:20480
  v_mfma_f32_16x16x32_bf16 v[36:39], v[132:135], v[120:123], v[36:39]
  ds_read_b64_tr_b16 v[186:187], v200 offset:20992
  v_mfma_f32_16x16x32_bf16 v[64:67], v[136:139], v[120:123], v[64:67]
  ds_read_b64_tr_b16 v[188:189], v201 offset:20480
  v_mfma_f32_16x16x32_bf16 v[68:71], v[140:143], v[120:123], v[68:71]
  ds_read_b64_tr_b16 v[190:191], v201 offset:20992
  v_mfma_f32_16x16x32_bf16 v[96:99], v[120:123], v[144:147], v[96:99]
  v_mfma_f32_16x16x32_bf16 v[100:103], v[120:123], v[148:151], v[100:103]
  v_mfma_f32_16x16x32_bf16 v[40:43], v[128:131], v[124:127], v[40:43]
  v_mfma_f32_16x16x32_bf16 v[44:47], v[132:135], v[124:127], v[44:47]
  v_mfma_f32_16x16x32_bf16 v[72:75], v[136:139], v[124:127], v[72:75]
  v_mfma_f32_16x16x32_bf16 v[76:79], v[140:143], v[124:127], v[76:79]
  v_mfma_f32_16x16x32_bf16 v[104:107], v[124:127], v[144:147], v[104:107]
  v_mfma_f32_16x16x32_bf16 v[108:111], v[124:127], v[148:151], v[108:111]
  s_waitcnt lgkmcnt(0)
  s_barrier
  v_mfma_f32_16x16x32_bf16 v[16:19], v[168:171], v[152:155], v[16:19]
  ds_read_b128 v[112:115], v198 offset:40960
  v_mfma_f32_16x16x32_bf16 v[20:23], v[172:175], v[152:155], v[20:23]
  ds_read_b128 v[116:119], v198 offset:43008
  v_mfma_f32_16x16x32_bf16 v[48:51], v[176:179], v[152:155], v[48:51]
  ds_read_b128 v[120:123], v198 offset:45056
  v_mfma_f32_16x16x32_bf16 v[52:55], v[180:183], v[152:155], v[52:55]
  ds_read_b128 v[124:127], v198 offset:47104
  v_mfma_f32_16x16x32_bf16 v[80:83], v[152:155], v[184:187], v[80:83]
  ds_read_b64_tr_b16 v[128:129], v200 offset:40960
  v_mfma_f32_16x16x32_bf16 v[84:87], v[152:155], v[188:191], v[84:87]
  ds_read_b64_tr_b16 v[130:131], v200 offset:41472
  v_mfma_f32_16x16x32_bf16 v[24:27], v[168:171], v[156:159], v[24:27]
  ds_read_b64_tr_b16 v[132:133], v201 offset:40960
  v_mfma_f32_16x16x32_bf16 v[28:31], v[172:175], v[156:159], v[28:31]
  ds_read_b64_tr_b16 v[134:135], v201 offset:41472
  v_mfma_f32_16x16x32_bf16 v[56:59], v[176:179], v[156:159], v[56:59]
  ds_read_b64_tr_b16 v[136:137], v200 offset:49152
  v_mfma_f32_16x16x32_bf16 v[60:63], v[180:183], v[156:159], v[60:63]
  ds_read_b64_tr_b16 v[138:139], v200 offset:49664
  v_mfma_f32_16x16x32_bf16 v[88:91], v[156:159], v[184:187], v[88:91]
  ds_read_b64_tr_b16 v[140:141], v201 offset:49152
  v_mfma_f32_16x16x32_bf16 v[92:95], v[156:159], v[188:191], v[92:95]
  ds_read_b64_tr_b16 v[142:143], v201 offset:49664
  v_mfma_f32_16x16x32_bf16 v[32:35], v[168:171], v[160:163], v[32:35]
  ds_read_b64_tr_b16 v[144:145], v200 offset:57344
  v_mfma_f32_16x16x32_bf16 v[36:39], v[172:175], v[160:163], v[36:39]
  ds_read_b64_tr_b16 v[146:147], v200 offset:57856
  v_mfma_f32_16x16x32_bf16 v[64:67], v[176:179], v[160:163], v[64:67]
  ds_read_b64_tr_b16 v[148:149], v201 offset:57344
  v_mfma_f32_16x16x32_bf16 v[68:71], v[180:183], v[160:163], v[68:71]
  ds_read_b64_tr_b16 v[150:151], v201 offset:57856
  v_mfma_f32_16x16x32_bf16 v[96:99], v[160:163], v[184:187], v[96:99]
  v_mfma_f32_16x16x32_bf16 v[100:103], v[160:163], v[188:191], v[100:103]
  v_mfma_f32_16x16x32_bf16 v[40:43], v[168:171], v[164:167], v[40:43]
  v_mfma_f32_16x16x32_bf16 v[44:47], v[172:175], v[164:167], v[44:47]
  v_mfma_f32_16x16x32_bf16 v[72:75], v[176:179], v[164:167], v[72:75]
  v_mfma_f32_16x16x32_bf16 v[76:79], v[180:183], v[164:167], v[76:79]
  v_mfma_f32_16x16x32_bf16 v[104:107], v[164:167], v[184:187], v[104:107]
  v_mfma_f32_16x16x32_bf16 v[108:111], v[164:167], v[188:191], v[108:111]
  s_waitcnt lgkmcnt(0)
  v_mfma_f32_16x16x32_bf16 v[16:19], v[128:131], v[112:115], v[16:19]
  ds_read_b128 v[152:155], v199 offset:40960
  v_mfma_f32_16x16x32_bf16 v[20:23], v[132:135], v[112:115], v[20:23]
  ds_read_b128 v[156:159], v199 offset:43008
  v_mfma_f32_16x16x32_bf16 v[48:51], v[136:139], v[112:115], v[48:51]
  ds_read_b128 v[160:163], v199 offset:45056
  v_mfma_f32_16x16x32_bf16 v[52:55], v[140:143], v[112:115], v[52:55]
  ds_read_b128 v[164:167], v199 offset:47104
  v_mfma_f32_16x16x32_bf16 v[80:83], v[112:115], v[144:147], v[80:83]
  ds_read_b64_tr_b16 v[168:169], v200 offset:45056
  v_mfma_f32_16x16x32_bf16 v[84:87], v[112:115], v[148:151], v[84:87]
  ds_read_b64_tr_b16 v[170:171], v200 offset:45568
  v_mfma_f32_16x16x32_bf16 v[24:27], v[128:131], v[116:119], v[24:27]
  ds_read_b64_tr_b16 v[172:173], v201 offset:45056
  v_mfma_f32_16x16x32_bf16 v[28:31], v[132:135], v[116:119], v[28:31]
  ds_read_b64_tr_b16 v[174:175], v201 offset:45568
  v_mfma_f32_16x16x32_bf16 v[56:59], v[136:139], v[116:119], v[56:59]
  ds_read_b64_tr_b16 v[176:177], v200 offset:53248
  v_mfma_f32_16x16x32_bf16 v[60:63], v[140:143], v[116:119], v[60:63]
  ds_read_b64_tr_b16 v[178:179], v200 offset:53760
  v_mfma_f32_16x16x32_bf16 v[88:91], v[116:119], v[144:147], v[88:91]
  ds_read_b64_tr_b16 v[180:181], v201 offset:53248
  v_mfma_f32_16x16x32_bf16 v[92:95], v[116:119], v[148:151], v[92:95]
  ds_read_b64_tr_b16 v[182:183], v201 offset:53760
  v_mfma_f32_16x16x32_bf16 v[32:35], v[128:131], v[120:123], v[32:35]
  ds_read_b64_tr_b16 v[184:185], v200 offset:61440
  v_mfma_f32_16x16x32_bf16 v[36:39], v[132:135], v[120:123], v[36:39]
  ds_read_b64_tr_b16 v[186:187], v200 offset:61952
  v_mfma_f32_16x16x32_bf16 v[64:67], v[136:139], v[120:123], v[64:67]
  ds_read_b64_tr_b16 v[188:189], v201 offset:61440
  v_mfma_f32_16x16x32_bf16 v[68:71], v[140:143], v[120:123], v[68:71]
  ds_read_b64_tr_b16 v[190:191], v201 offset:61952
  v_mfma_f32_16x16x32_bf16 v[96:99], v[120:123], v[144:147], v[96:99]
  v_mfma_f32_16x16x32_bf16 v[100:103], v[120:123], v[148:151], v[100:103]
  v_mfma_f32_16x16x32_bf16 v[40:43], v[128:131], v[124:127], v[40:43]
  v_mfma_f32_16x16x32_bf16 v[44:47], v[132:135], v[124:127], v[44:47]
  v_mfma_f32_16x16x32_bf16 v[72:75], v[136:139], v[124:127], v[72:75]
  v_mfma_f32_16x16x32_bf16 v[76:79], v[140:143], v[124:127], v[76:79]
  v_mfma_f32_16x16x32_bf16 v[104:107], v[124:127], v[144:147], v[104:107]
  v_mfma_f32_16x16x32_bf16 v[108:111], v[124:127], v[148:151], v[108:111]
  s_waitcnt lgkmcnt(0)
  v_mfma_f32_16x16x32_bf16 v[16:19], v[168:171], v[152:155], v[16:19]
  v_mfma_f32_16x16x32_bf16 v[20:23], v[172:175], v[152:155], v[20:23]
  v_mfma_f32_16x16x32_bf16 v[48:51], v[176:179], v[152:155], v[48:51]
  v_mfma_f32_16x16x32_bf16 v[52:55], v[180:183], v[152:155], v[52:55]
  v_mfma_f32_16x16x32_bf16 v[80:83], v[152:155], v[184:187], v[80:83]
  v_mfma_f32_16x16x32_bf16 v[84:87], v[152:155], v[188:191], v[84:87]
  v_mfma_f32_16x16x32_bf16 v[24:27], v[168:171], v[156:159], v[24:27]
  v_mfma_f32_16x16x32_bf16 v[28:31], v[172:175], v[156:159], v[28:31]
  v_mfma_f32_16x16x32_bf16 v[56:59], v[176:179], v[156:159], v[56:59]
  v_mfma_f32_16x16x32_bf16 v[60:63], v[180:183], v[156:159], v[60:63]
  v_mfma_f32_16x16x32_bf16 v[88:91], v[156:159], v[184:187], v[88:91]
  v_mfma_f32_16x16x32_bf16 v[92:95], v[156:159], v[188:191], v[92:95]
  v_mfma_f32_16x16x32_bf16 v[32:35], v[168:171], v[160:163], v[32:35]
  v_mfma_f32_16x16x32_bf16 v[36:39], v[172:175], v[160:163], v[36:39]
  v_mfma_f32_16x16x32_bf16 v[64:67], v[176:179], v[160:163], v[64:67]
  v_mfma_f32_16x16x32_bf16 v[68:71], v[180:183], v[160:163], v[68:71]
  v_mfma_f32_16x16x32_bf16 v[96:99], v[160:163], v[184:187], v[96:99]
  v_mfma_f32_16x16x32_bf16 v[100:103], v[160:163], v[188:191], v[100:103]
  v_mfma_f32_16x16x32_bf16 v[40:43], v[168:171], v[164:167], v[40:43]
  v_mfma_f32_16x16x32_bf16 v[44:47], v[172:175], v[164:167], v[44:47]
  v_mfma_f32_16x16x32_bf16 v[72:75], v[176:179], v[164:167], v[72:75]
  v_mfma_f32_16x16x32_bf16 v[76:79], v[180:183], v[164:167], v[76:79]
  v_mfma_f32_16x16x32_bf16 v[104:107], v[164:167], v[184:187], v[104:107]
  v_mfma_f32_16x16x32_bf16 v[108:111], v[164:167], v[188:191], v[108:111]
  s_mov_b32 s37, 0
standalone__softmax_full_mha__prompt_kernel_nwait:
  s_waitcnt vmcnt(0)
  v_readfirstlane_b32 s48, v196
  s_add_u32 s37, s37, 1
  s_cmp_lg_u32 s48, 0
  s_cbranch_scc1 standalone__softmax_full_mha__prompt_kernel_ngot
  s_cmp_gt_u32 s37, 200000
  s_cbranch_scc1 standalone__softmax_full_mha__prompt_kernel_ngot
  global_load_dword v196, v197, s[8:9] sc1
  s_sleep 1
  s_branch standalone__softmax_full_mha__prompt_kernel_nwait
standalone__softmax_full_mha__prompt_kernel_ngot:
  s_lshl_b32 s42, s17, 1
  s_add_u32 s42, s42, s40
  s_lshl_b32 s43, s16, 2
  s_lshl_b32 s36, s41, 1
  s_add_u32 s43, s43, s36
  s_mov_b32 s54, 1048744942
  v_lshlrev_b32 v1, 4, v0
  s_lshl_b32 s36, s42, 6
  s_add_u32 s36, s36, s43
  s_lshl_b32 s55, s36, 12
  s_add_u32 s55, s55, 4194304
  s_lshl_b32 s36, s18, 13
  s_add_u32 s36, s36, 16384
  v_add_u32 v2, s36, v1
  s_lshl_b32 s36, s18, 12
  v_add_u32 v3, s36, v1
  v_cvt_pk_bf16_f32 v120, v48, v49
  v_cvt_pk_bf16_f32 v121, v50, v51
  v_cvt_pk_bf16_f32 v122, v56, v57
  v_cvt_pk_bf16_f32 v123, v58, v59
  v_cvt_pk_bf16_f32 v124, v52, v53
  v_cvt_pk_bf16_f32 v125, v54, v55
  v_cvt_pk_bf16_f32 v126, v60, v61
  v_cvt_pk_bf16_f32 v127, v62, v63
  s_nop 0
  v_permlane16_swap_b32 v120, v122
  v_permlane16_swap_b32 v121, v123
  v_permlane16_swap_b32 v124, v126
  v_permlane16_swap_b32 v125, v127
  v_cvt_pk_bf16_f32 v128, v80, v81
  v_cvt_pk_bf16_f32 v129, v82, v83
  v_cvt_pk_bf16_f32 v130, v84, v85
  v_cvt_pk_bf16_f32 v131, v86, v87
  v_cvt_pk_bf16_f32 v132, v88, v89
  v_cvt_pk_bf16_f32 v133, v90, v91
  v_cvt_pk_bf16_f32 v134, v92, v93
  v_cvt_pk_bf16_f32 v135, v94, v95
  s_nop 0
  v_permlane16_swap_b32 v128, v130
  v_permlane16_swap_b32 v129, v131
  v_permlane16_swap_b32 v132, v134
  v_permlane16_swap_b32 v133, v135
  s_nop 0
  v_permlane32_swap_b32 v128, v130
  v_permlane32_swap_b32 v129, v131
  v_permlane32_swap_b32 v132, v134
  v_permlane32_swap_b32 v133, v135
  s_nop 0
  buffer_store_dwordx4 v[120:123], v1, s[28:31], s55 offen offset:0 sc1
  buffer_store_dwordx4 v[124:127], v1, s[28:31], s55 offen offset:1024 sc1
  buffer_store_dwordx4 v[128:131], v1, s[28:31], s55 offen offset:2048 sc1
  buffer_store_dwordx4 v[132:135], v1, s[28:31], s55 offen offset:3072 sc1
  ds_write_b128 v2, v[120:123] offset:0
  ds_write_b128 v2, v[124:127] offset:1024
  ds_write_b128 v2, v[128:131] offset:2048
  ds_write_b128 v2, v[132:135] offset:3072
  s_add_u32 s55, s55, 4096
  v_cvt_pk_bf16_f32 v144, v64, v65
  v_cvt_pk_bf16_f32 v145, v66, v67
  v_cvt_pk_bf16_f32 v146, v72, v73
  v_cvt_pk_bf16_f32 v147, v74, v75
  v_cvt_pk_bf16_f32 v148, v68, v69
  v_cvt_pk_bf16_f32 v149, v70, v71
  v_cvt_pk_bf16_f32 v150, v76, v77
  v_cvt_pk_bf16_f32 v151, v78, v79
  s_nop 0
  v_permlane16_swap_b32 v144, v146
  v_permlane16_swap_b32 v145, v147
  v_permlane16_swap_b32 v148, v150
  v_permlane16_swap_b32 v149, v151
  v_cvt_pk_bf16_f32 v152, v96, v97
  v_cvt_pk_bf16_f32 v153, v98, v99
  v_cvt_pk_bf16_f32 v154, v100, v101
  v_cvt_pk_bf16_f32 v155, v102, v103
  v_cvt_pk_bf16_f32 v156, v104, v105
  v_cvt_pk_bf16_f32 v157, v106, v107
  v_cvt_pk_bf16_f32 v158, v108, v109
  v_cvt_pk_bf16_f32 v159, v110, v111
  s_nop 0
  v_permlane16_swap_b32 v152, v154
  v_permlane16_swap_b32 v153, v155
  v_permlane16_swap_b32 v156, v158
  v_permlane16_swap_b32 v157, v159
  s_nop 0
  v_permlane32_swap_b32 v152, v154
  v_permlane32_swap_b32 v153, v155
  v_permlane32_swap_b32 v156, v158
  v_permlane32_swap_b32 v157, v159
  s_nop 0
  buffer_store_dwordx4 v[144:147], v1, s[28:31], s55 offen offset:0 sc1
  buffer_store_dwordx4 v[148:151], v1, s[28:31], s55 offen offset:1024 sc1
  buffer_store_dwordx4 v[152:155], v1, s[28:31], s55 offen offset:2048 sc1
  buffer_store_dwordx4 v[156:159], v1, s[28:31], s55 offen offset:3072 sc1
  ds_write_b128 v2, v[144:147] offset:4096
  ds_write_b128 v2, v[148:151] offset:5120
  ds_write_b128 v2, v[152:155] offset:6144
  ds_write_b128 v2, v[156:159] offset:7168
  v_mul_f32 v16, s54, v16
  v_mul_f32 v17, s54, v17
  v_mul_f32 v18, s54, v18
  v_mul_f32 v19, s54, v19
  v_mul_f32 v20, s54, v20
  v_mul_f32 v21, s54, v21
  v_mul_f32 v22, s54, v22
  v_mul_f32 v23, s54, v23
  v_mul_f32 v24, s54, v24
  v_mul_f32 v25, s54, v25
  v_mul_f32 v26, s54, v26
  v_mul_f32 v27, s54, v27
  v_mul_f32 v28, s54, v28
  v_mul_f32 v29, s54, v29
  v_mul_f32 v30, s54, v30
  v_mul_f32 v31, s54, v31
  v_cvt_pk_bf16_f32 v112, v16, v17
  v_cvt_pk_bf16_f32 v113, v18, v19
  v_cvt_pk_bf16_f32 v114, v24, v25
  v_cvt_pk_bf16_f32 v115, v26, v27
  v_cvt_pk_bf16_f32 v116, v20, v21
  v_cvt_pk_bf16_f32 v117, v22, v23
  v_cvt_pk_bf16_f32 v118, v28, v29
  v_cvt_pk_bf16_f32 v119, v30, v31
  s_nop 0
  v_permlane16_swap_b32 v112, v114
  v_permlane16_swap_b32 v113, v115
  v_permlane16_swap_b32 v116, v118
  v_permlane16_swap_b32 v117, v119
  s_nop 0
  ds_write_b128 v3, v[112:115] offset:0
  ds_write_b128 v3, v[116:119] offset:1024
  v_mul_f32 v32, s54, v32
  v_mul_f32 v33, s54, v33
  v_mul_f32 v34, s54, v34
  v_mul_f32 v35, s54, v35
  v_mul_f32 v36, s54, v36
  v_mul_f32 v37, s54, v37
  v_mul_f32 v38, s54, v38
  v_mul_f32 v39, s54, v39
  v_mul_f32 v40, s54, v40
  v_mul_f32 v41, s54, v41
  v_mul_f32 v42, s54, v42
  v_mul_f32 v43, s54, v43
  v_mul_f32 v44, s54, v44
  v_mul_f32 v45, s54, v45
  v_mul_f32 v46, s54, v46
  v_mul_f32 v47, s54, v47
  v_cvt_pk_bf16_f32 v136, v32, v33
  v_cvt_pk_bf16_f32 v137, v34, v35
  v_cvt_pk_bf16_f32 v138, v40, v41
  v_cvt_pk_bf16_f32 v139, v42, v43
  v_cvt_pk_bf16_f32 v140, v36, v37
  v_cvt_pk_bf16_f32 v141, v38, v39
  v_cvt_pk_bf16_f32 v142, v44, v45
  v_cvt_pk_bf16_f32 v143, v46, v47
  s_nop 0
  v_permlane16_swap_b32 v136, v138
  v_permlane16_swap_b32 v137, v139
  v_permlane16_swap_b32 v140, v142
  v_permlane16_swap_b32 v141, v143
  s_nop 0
  ds_write_b128 v3, v[136:139] offset:2048
  ds_write_b128 v3, v[140:143] offset:3072
  v_mov_b32 v16, s48
  v_mov_b32 v4, 49152
  s_mov_b64 exec, 1
  ds_write_b32 v4, v16
  s_mov_b64 exec, -1
  v_and_b32 v2, 3, v0
  v_cmp_gt_u32 vcc, 2, v2
  v_bfe_u32 v3, v0, 2, 1
  v_cmp_eq_u32 s[56:57], 0, v3
  s_nop 1
  s_and_b64 s[58:59], vcc, s[56:57]
  s_andn2_b64 s[56:57], vcc, s[56:57]
  v_mov_b32 v4, 0x3f803f80
  v_cndmask_b32 v200, 0, v4, s[58:59]
  v_cndmask_b32 v201, 0, v4, s[58:59]
  v_cndmask_b32 v202, 0, v4, s[56:57]
  v_cndmask_b32 v203, 0, v4, s[56:57]
  v_mov_b32 v204, 0x4444
  v_mov_b32 v4, 0xeeee
  v_cmp_eq_u32 vcc, 1, v2
  s_nop 1
  v_cndmask_b32 v204, v204, v4, vcc
  s_waitcnt lgkmcnt(0)
standalone__softmax_full_mha__prompt_kernel_join:
  s_lshr_b32 s12, s18, 2
  s_and_b32 s19, s18, 3
  s_lshl_b32 s14, s17, 1
  s_add_u32 s14, s14, s12
  s_barrier
  s_add_u32 s36, s19, 1
  s_and_b32 s36, s36, 3
  s_lshl_b32 s37, s12, 2
  s_add_u32 s36, s36, s37
  s_lshl_b32 s36, s36, 11
  v_add_u32 v2, s36, v1
  ds_read_b128 v[8:11], v2 offset:0
  ds_read_b128 v[12:15], v2 offset:1024
  s_add_u32 s36, s19, 2
  s_and_b32 s36, s36, 3
  s_lshl_b32 s37, s12, 2
  s_add_u32 s36, s36, s37
  s_lshl_b32 s36, s36, 11
  v_add_u32 v2, s36, v1
  ds_read_b128 v[16:19], v2 offset:0
  ds_read_b128 v[20:23], v2 offset:1024
  s_add_u32 s36, s19, 3
  s_and_b32 s36, s36, 3
  s_lshl_b32 s37, s12, 2
  s_add_u32 s36, s36, s37
  s_lshl_b32 s36, s36, 11
  v_add_u32 v2, s36, v1
  ds_read_b128 v[24:27], v2 offset:0
  ds_read_b128 v[28:31], v2 offset:1024
  s_add_u32 s36, s19, 4
  s_and_b32 s36, s36, 3
  s_lshl_b32 s37, s12, 2
  s_add_u32 s36, s36, s37
  s_lshl_b32 s36, s36, 11
  v_add_u32 v2, s36, v1
  ds_read_b128 v[32:35], v2 offset:0
  ds_read_b128 v[36:39], v2 offset:1024
  s_lshl_b32 s36, s18, 12
  s_add_u32 s36, s36, 16384
  v_add_u32 v2, s36, v1
  ds_read_b128 v[40:43], v2
  ds_read_b128 v[44:47], v2 offset:1024
  ds_read_b128 v[56:59], v2 offset:2048
  ds_read_b128 v[60:63], v2 offset:3072
  v_mov_b32 v2, 49152
  ds_read_b32 v88, v2
  s_cmp_ge_u32 s18, 4
  s_cbranch_scc1 standalone__softmax_full_mha__prompt_kernel_nopub
  v_mov_b32 v184, 0
  v_mov_b32 v185, 0
  v_mov_b32 v186, 0
  v_mov_b32 v187, 0
  v_mov_b32 v188, 0
  v_mov_b32 v189, 0
  s_nop 0
  v_dot2_f32_bf16 v184, v112, v112, v184
  v_dot2_f32_bf16 v185, v120, v120, v185
  v_dot2_f32_bf16 v186, v128, v128, v186
  v_dot2_f32_bf16 v187, v136, v136, v187
  v_dot2_f32_bf16 v188, v144, v144, v188
  v_dot2_f32_bf16 v189, v152, v152, v189
  v_dot2_f32_bf16 v184, v113, v113, v184
  v_dot2_f32_bf16 v185, v121, v121, v185
  v_dot2_f32_bf16 v186, v129, v129, v186
  v_dot2_f32_bf16 v187, v137, v137, v187
  v_dot2_f32_bf16 v188, v145, v145, v188
  v_dot2_f32_bf16 v189, v153, v153, v189
  v_dot2_f32_bf16 v184, v114, v114, v184
  v_dot2_f32_bf16 v185, v122, v122, v185
  v_dot2_f32_bf16 v186, v130, v130, v186
  v_dot2_f32_bf16 v187, v138, v138, v187
  v_dot2_f32_bf16 v188, v146, v146, v188
  v_dot2_f32_bf16 v189, v154, v154, v189
  v_dot2_f32_bf16 v184, v115, v115, v184
  v_dot2_f32_bf16 v185, v123, v123, v185
  v_dot2_f32_bf16 v186, v131, v131, v186
  v_dot2_f32_bf16 v187, v139, v139, v187
  v_dot2_f32_bf16 v188, v147, v147, v188
  v_dot2_f32_bf16 v189, v155, v155, v189
  v_dot2_f32_bf16 v184, v116, v116, v184
  v_dot2_f32_bf16 v185, v124, v124, v185
  v_dot2_f32_bf16 v186, v132, v132, v186
  v_dot2_f32_bf16 v187, v140, v140, v187
  v_dot2_f32_bf16 v188, v148, v148, v188
  v_dot2_f32_bf16 v189, v156, v156, v189
  v_dot2_f32_bf16 v184, v117, v117, v184
  v_dot2_f32_bf16 v185, v125, v125, v185
  v_dot2_f32_bf16 v186, v133, v133, v186
  v_dot2_f32_bf16 v187, v141, v141, v187
  v_dot2_f32_bf16 v188, v149, v149, v188
  v_dot2_f32_bf16 v189, v157, v157, v189
  v_dot2_f32_bf16 v184, v118, v118, v184
  v_dot2_f32_bf16 v185, v126, v126, v185
  v_dot2_f32_bf16 v186, v134, v134, v186
  v_dot2_f32_bf16 v187, v142, v142, v187
  v_dot2_f32_bf16 v188, v150, v150, v188
  v_dot2_f32_bf16 v189, v158, v158, v189
  v_dot2_f32_bf16 v184, v119, v119, v184
  v_dot2_f32_bf16 v185, v127, v127, v185
  v_dot2_f32_bf16 v186, v135, v135, v186
  v_dot2_f32_bf16 v187, v143, v143, v187
  v_dot2_f32_bf16 v188, v151, v151, v188
  v_dot2_f32_bf16 v189, v159, v159, v189
  s_nop 3
  v_mov_b32 v192, v184
  v_mov_b32 v193, v185
  v_mov_b32 v194, v187
  v_mov_b32 v195, v188
  s_nop 1
  v_permlane32_swap_b32 v184, v192
  v_permlane32_swap_b32 v185, v193
  v_permlane32_swap_b32 v187, v194
  v_permlane32_swap_b32 v188, v195
  s_nop 1
  v_add_f32 v184, v184, v192
  v_add_f32 v185, v185, v193
  v_add_f32 v187, v187, v194
  v_add_f32 v188, v188, v195
  v_max_f32 v184, v184, v187
  v_max_f32 v185, v185, v188
  v_max_f32 v186, v186, v189
  s_nop 1
  v_max_f32_dpp v184, v184, v184 row_shr:1 row_mask:0xf bank_mask:0xf bound_ctrl:0
  v_max_f32_dpp v185, v185, v185 row_shr:1 row_mask:0xf bank_mask:0xf bound_ctrl:0
  v_max_f32_dpp v186, v186, v186 row_shr:1 row_mask:0xf bank_mask:0xf bound_ctrl:0
  s_nop 1
  v_max_f32_dpp v184, v184, v184 row_shr:2 row_mask:0xf bank_mask:0xf bound_ctrl:0
  v_max_f32_dpp v185, v185, v185 row_shr:2 row_mask:0xf bank_mask:0xf bound_ctrl:0
  v_max_f32_dpp v186, v186, v186 row_shr:2 row_mask:0xf bank_mask:0xf bound_ctrl:0
  s_nop 1
  v_max_f32_dpp v184, v184, v184 row_shr:4 row_mask:0xf bank_mask:0xf bound_ctrl:0
  v_max_f32_dpp v185, v185, v185 row_shr:4 row_mask:0xf bank_mask:0xf bound_ctrl:0
  v_max_f32_dpp v186, v186, v186 row_shr:4 row_mask:0xf bank_mask:0xf bound_ctrl:0
  s_nop 1
  v_max_f32_dpp v184, v184, v184 row_shr:8 row_mask:0xf bank_mask:0xf bound_ctrl:0
  v_max_f32_dpp v185, v185, v185 row_shr:8 row_mask:0xf bank_mask:0xf bound_ctrl:0
  v_max_f32_dpp v186, v186, v186 row_shr:8 row_mask:0xf bank_mask:0xf bound_ctrl:0
  s_nop 1
  v_max_f32_dpp v184, v184, v184 row_bcast:15 row_mask:0xa bank_mask:0xf
  v_max_f32_dpp v185, v185, v185 row_bcast:15 row_mask:0xa bank_mask:0xf
  v_max_f32_dpp v186, v186, v186 row_bcast:15 row_mask:0xa bank_mask:0xf
  s_nop 1
  v_max_f32_dpp v184, v184, v184 row_bcast:31 row_mask:0xc bank_mask:0xf
  v_max_f32_dpp v185, v185, v185 row_bcast:31 row_mask:0xc bank_mask:0xf
  v_max_f32_dpp v186, v186, v186 row_bcast:31 row_mask:0xc bank_mask:0xf
  v_mov_b32 v212, s48
  v_mov_b32 v213, v185
  v_mov_b32 v214, v186
  v_mov_b32 v215, 0
  s_lshl_b32 s36, s17, 4
  s_add_u32 s36, s36, s16
  s_lshl_b32 s36, s36, 2
  s_add_u32 s36, s36, s18
  s_lshl_b32 s36, s36, 7
  s_add_u32 s37, s36, 18219008
  s_add_u32 s36, s36, 17825792
  v_mov_b32 v2, 0
  s_lshl_b32 s54, s18, 2
  s_add_u32 s54, s54, 57344
  v_mov_b32 v3, s54
  s_waitcnt vmcnt(0)
  v_cmp_eq_u32 vcc, 63, v0
  s_and_saveexec_b64 s[56:57], vcc
  buffer_store_dword v212, v2, s[28:31], s36 offen sc1
  buffer_store_dwordx4 v[212:215], v2, s[28:31], s37 offen sc1
  ds_write_b32 v3, v184
  s_mov_b64 exec, s[56:57]
  v_mov_b32 v104, 0
  v_mov_b32 v105, 0
  v_mov_b32 v106, 0
  v_mov_b32 v107, 0
  v_mov_b32 v108, 0
  v_mov_b32 v109, 0
  v_mov_b32 v110, 0
  v_mov_b32 v111, 0
  v_mov_b32 v112, 0
  v_mov_b32 v113, 0
  v_mov_b32 v114, 0
  v_mov_b32 v115, 0
  v_mov_b32 v116, 0
  v_mov_b32 v117, 0
  v_mov_b32 v118, 0
  v_mov_b32 v119, 0
  v_mov_b32 v120, 0
  v_mov_b32 v121, 0
  v_mov_b32 v122, 0
  v_mov_b32 v123, 0
  v_mov_b32 v124, 0
  v_mov_b32 v125, 0
  v_mov_b32 v126, 0
  v_mov_b32 v127, 0
  v_mov_b32 v128, 0
  v_mov_b32 v129, 0
  v_mov_b32 v130, 0
  v_mov_b32 v131, 0
  v_mov_b32 v132, 0
  v_mov_b32 v133, 0
  v_mov_b32 v134, 0
  v_mov_b32 v135, 0
  v_mov_b32 v136, 0
  v_mov_b32 v137, 0
  v_mov_b32 v138, 0
  v_mov_b32 v139, 0
  v_mov_b32 v140, 0
  v_mov_b32 v141, 0
  v_mov_b32 v142, 0
  v_mov_b32 v143, 0
  v_mov_b32 v144, 0
  v_mov_b32 v145, 0
  v_mov_b32 v146, 0
  v_mov_b32 v147, 0
  v_mov_b32 v148, 0
  v_mov_b32 v149, 0
  v_mov_b32 v150, 0
  v_mov_b32 v151, 0
  v_mov_b32 v152, 0
  v_mov_b32 v153, 0
  v_mov_b32 v154, 0
  v_mov_b32 v155, 0
  v_mov_b32 v156, 0
  v_mov_b32 v157, 0
  v_mov_b32 v158, 0
  v_mov_b32 v159, 0
  v_mov_b32 v160, 0
  v_mov_b32 v161, 0
  v_mov_b32 v162, 0
  v_mov_b32 v163, 0
  v_mov_b32 v164, 0
  v_mov_b32 v165, 0
  v_mov_b32 v166, 0
  v_mov_b32 v167, 0
  v_mov_b32 v168, 0
  v_mov_b32 v169, 0
  v_mov_b32 v170, 0
  v_mov_b32 v171, 0
  v_mov_b32 v172, 0
  v_mov_b32 v173, 0
  v_mov_b32 v174, 0
  v_mov_b32 v175, 0
  v_mov_b32 v176, 0
  v_mov_b32 v177, 0
  v_mov_b32 v178, 0
  v_mov_b32 v179, 0
  v_mov_b32 v180, 0
  v_mov_b32 v181, 0
  v_mov_b32 v182, 0
  v_mov_b32 v183, 0
  v_mov_b32 v184, 0
  v_mov_b32 v185, 0
  v_mov_b32 v186, 0
  v_mov_b32 v187, 0
  v_mov_b32 v188, 0
  v_mov_b32 v189, 0
  v_mov_b32 v190, 0
  v_mov_b32 v191, 0
  v_mov_b32 v192, 0
  v_mov_b32 v193, 0
  v_mov_b32 v194, 0
  v_mov_b32 v195, 0
  v_mov_b32 v196, 0
  v_mov_b32 v197, 0
  v_mov_b32 v198, 0
  v_mov_b32 v199, 0
standalone__softmax_full_mha__prompt_kernel_nopub:
  s_waitcnt lgkmcnt(0)
  v_readfirstlane_b32 s48, v88
  s_lshl_b32 s60, s17, 13
  s_add_u32 s15, s60, 18219008
  s_add_u32 s60, s60, 17825792
  v_lshlrev_b32 v216, 7, v0
  s_lshl_b32 s61, s12, 1
  s_lshr_b32 s36, s19, 1
  s_add_u32 s61, s61, s36
  v_mfma_f32_32x32x16_bf16 v[72:87], v[40:43], v[8:11], 0
  v_mfma_f32_32x32x16_bf16 v[72:87], v[44:47], v[12:15], v[72:87]
  s_nop 15
  v_mfma_f32_32x32x16_bf16 v[88:103], v[40:43], v[16:19], 0
  v_exp_f32 v72, v72
  v_exp_f32 v73, v73
  v_exp_f32 v74, v74
  v_mfma_f32_32x32x16_bf16 v[88:103], v[44:47], v[20:23], v[88:103]
  v_exp_f32 v75, v75
  v_exp_f32 v76, v76
  v_exp_f32 v77, v77
  v_exp_f32 v78, v78
  v_exp_f32 v79, v79
  v_cvt_pk_bf16_f32 v104, v72, v73
  v_cvt_pk_bf16_f32 v105, v74, v75
  v_cvt_pk_bf16_f32 v106, v76, v77
  v_cvt_pk_bf16_f32 v107, v78, v79
  v_exp_f32 v80, v80
  v_exp_f32 v81, v81
  v_mfma_f32_32x32x16_bf16 v[120:135], v[56:59], v[104:107], v[120:135]
  v_exp_f32 v82, v82
  v_exp_f32 v83, v83
  v_exp_f32 v84, v84
  v_exp_f32 v85, v85
  v_exp_f32 v86, v86
  v_exp_f32 v87, v87
  v_cvt_pk_bf16_f32 v108, v80, v81
  v_cvt_pk_bf16_f32 v109, v82, v83
  v_cvt_pk_bf16_f32 v110, v84, v85
  v_cvt_pk_bf16_f32 v111, v86, v87
  v_mfma_f32_32x32x16_bf16 v[72:87], v[40:43], v[24:27], 0
  v_exp_f32 v88, v88
  v_exp_f32 v89, v89
  v_exp_f32 v90, v90
  v_mfma_f32_32x32x16_bf16 v[72:87], v[44:47], v[28:31], v[72:87]
  v_exp_f32 v91, v91
  v_exp_f32 v92, v92
  v_exp_f32 v93, v93
  v_mfma_f32_32x32x16_bf16 v[120:135], v[60:63], v[108:111], v[120:135]
  v_exp_f32 v94, v94
  v_exp_f32 v95, v95
  v_cvt_pk_bf16_f32 v112, v88, v89
  v_cvt_pk_bf16_f32 v113, v90, v91
  v_smfmac_f32_16x16x64_bf16 v[184:187], v[200:203], v[104:111], v204
  v_cvt_pk_bf16_f32 v114, v92, v93
  v_cvt_pk_bf16_f32 v115, v94, v95
  v_exp_f32 v96, v96
  v_exp_f32 v97, v97
  v_mfma_f32_32x32x16_bf16 v[136:151], v[56:59], v[112:115], v[136:151]
  v_exp_f32 v98, v98
  v_exp_f32 v99, v99
  v_exp_f32 v100, v100
  v_exp_f32 v101, v101
  v_exp_f32 v102, v102
  v_exp_f32 v103, v103
  v_cvt_pk_bf16_f32 v116, v96, v97
  v_cvt_pk_bf16_f32 v117, v98, v99
  v_cvt_pk_bf16_f32 v118, v100, v101
  v_cvt_pk_bf16_f32 v119, v102, v103
  v_mfma_f32_32x32x16_bf16 v[88:103], v[40:43], v[32:35], 0
  v_exp_f32 v72, v72
  v_exp_f32 v73, v73
  v_exp_f32 v74, v74
  v_mfma_f32_32x32x16_bf16 v[88:103], v[44:47], v[36:39], v[88:103]
  v_exp_f32 v75, v75
  v_exp_f32 v76, v76
  v_exp_f32 v77, v77
  v_mfma_f32_32x32x16_bf16 v[136:151], v[60:63], v[116:119], v[136:151]
  v_exp_f32 v78, v78
  v_exp_f32 v79, v79
  v_cvt_pk_bf16_f32 v104, v72, v73
  v_cvt_pk_bf16_f32 v105, v74, v75
  v_smfmac_f32_16x16x64_bf16 v[188:191], v[200:203], v[112:119], v204
  v_cvt_pk_bf16_f32 v106, v76, v77
  v_cvt_pk_bf16_f32 v107, v78, v79
  v_exp_f32 v80, v80
  v_exp_f32 v81, v81
  v_mfma_f32_32x32x16_bf16 v[152:167], v[56:59], v[104:107], v[152:167]
  v_exp_f32 v82, v82
  v_exp_f32 v83, v83
  v_exp_f32 v84, v84
  v_exp_f32 v85, v85
  v_exp_f32 v86, v86
  v_exp_f32 v87, v87
  v_cvt_pk_bf16_f32 v108, v80, v81
  v_cvt_pk_bf16_f32 v109, v82, v83
  v_cvt_pk_bf16_f32 v110, v84, v85
  v_cvt_pk_bf16_f32 v111, v86, v87
  buffer_load_dword v217, v216, s[28:31], s60 offen sc1
  v_exp_f32 v88, v88
  v_exp_f32 v89, v89
  v_exp_f32 v90, v90
  v_exp_f32 v91, v91
  v_exp_f32 v92, v92
  v_exp_f32 v93, v93
  v_mfma_f32_32x32x16_bf16 v[152:167], v[60:63], v[108:111], v[152:167]
  v_exp_f32 v94, v94
  v_exp_f32 v95, v95
  v_cvt_pk_bf16_f32 v112, v88, v89
  v_cvt_pk_bf16_f32 v113, v90, v91
  v_smfmac_f32_16x16x64_bf16 v[192:195], v[200:203], v[104:111], v204
  v_cvt_pk_bf16_f32 v114, v92, v93
  v_cvt_pk_bf16_f32 v115, v94, v95
  v_exp_f32 v96, v96
  v_exp_f32 v97, v97
  v_mfma_f32_32x32x16_bf16 v[168:183], v[56:59], v[112:115], v[168:183]
  v_exp_f32 v98, v98
  v_exp_f32 v99, v99
  v_exp_f32 v100, v100
  v_exp_f32 v101, v101
  v_exp_f32 v102, v102
  v_exp_f32 v103, v103
  v_cvt_pk_bf16_f32 v116, v96, v97
  v_cvt_pk_bf16_f32 v117, v98, v99
  v_cvt_pk_bf16_f32 v118, v100, v101
  v_cvt_pk_bf16_f32 v119, v102, v103
  s_nop 1
  v_mfma_f32_32x32x16_bf16 v[168:183], v[60:63], v[116:119], v[168:183]
  v_smfmac_f32_16x16x64_bf16 v[196:199], v[200:203], v[112:119], v204
  s_waitcnt vmcnt(0)
  v_cmp_eq_u32 vcc, s48, v217
  s_nop 0
  s_lshr_b64 s[62:63], vcc, s61
  s_and_b32 s62, s62, 0x11111111
  s_and_b32 s63, s63, 0x11111111
  s_lshl_b32 s41, s14, 6
  s_add_u32 s41, s41, s19
  s_lshl_b32 s41, s41, 12
  s_add_u32 s41, s41, 4194304
  s_lshl_b32 s36, s51, 7
  s_add_u32 s44, s44, s36
  s_addc_u32 s45, s45, 0
  s_mov_b32 s20, s44
  s_and_b32 s21, s45, 0xffff
  s_mov_b32 s22, 0
  s_mov_b32 s23, 0x00020000
  s_sub_u32 s22, 2097152, s36
  v_lshrrev_b32 v2, 3, v0
  v_and_b32 v3, 7, v0
  v_bfe_u32 v4, v2, 1, 2
  v_lshlrev_b32 v4, 1, v4
  v_xor_b32 v4, v4, v3
  v_lshlrev_b32 v4, 4, v4
  v_lshl_add_u32 v210, v2, 11, v4
  s_lshl_b32 s52, s18, 14
  s_lshl_b32 s53, s18, 10
  s_mov_b32 s13, 917504
  v_lshrrev_b32 v2, 4, v0
  v_bfe_u32 v3, v0, 2, 2
  v_and_b32 v6, 1, v2
  v_lshl_add_u32 v6, v6, 2, v3
  v_lshrrev_b32 v5, 1, v2
  v_lshl_add_u32 v5, v5, 4, v6
  v_lshlrev_b32 v5, 7, v5
  v_lshrrev_b32 v6, 1, v6
  v_and_b32 v3, 3, v0
  v_lshl_add_u32 v5, v3, 3, v5
  s_lshl_b32 s36, s18, 14
  v_add_u32 v5, s36, v5
  v_xor_b32 v7, 0, v6
  v_lshl_add_u32 v234, v7, 5, v5
  v_xor_b32 v7, 1, v6
  v_lshl_add_u32 v235, v7, 5, v5
  v_xor_b32 v7, 2, v6
  v_lshl_add_u32 v236, v7, 5, v5
  v_xor_b32 v7, 3, v6
  v_lshl_add_u32 v237, v7, 5, v5
  v_add_u32 v238, s36, v1
  s_add_u32 s36, s19, 1
  s_and_b32 s36, s36, 3
  s_lshl_b32 s37, s12, 2
  s_add_u32 s36, s36, s37
  s_mul_i32 s36, s36, 13056
  s_add_u32 s36, s36, 68096
  v_add_u32 v219, s36, v1
  v_lshrrev_b32 v2, 2, v1
  v_add_u32 v222, s36, v2
  s_add_u32 s36, s19, 2
  s_and_b32 s36, s36, 3
  s_lshl_b32 s37, s12, 2
  s_add_u32 s36, s36, s37
  s_mul_i32 s36, s36, 13056
  s_add_u32 s36, s36, 63744
  v_add_u32 v220, s36, v1
  v_lshrrev_b32 v2, 2, v1
  v_add_u32 v223, s36, v2
  s_add_u32 s36, s19, 3
  s_and_b32 s36, s36, 3
  s_lshl_b32 s37, s12, 2
  s_add_u32 s36, s36, s37
  s_mul_i32 s36, s36, 13056
  s_add_u32 s36, s36, 59392
  v_add_u32 v221, s36, v1
  v_lshrrev_b32 v2, 2, v1
  v_add_u32 v224, s36, v2
  s_barrier
  s_mov_b64 s[54:55], 0
  s_lshl_b32 s36, s16, 2
  s_bitset1_b64 s[54:55], s36
  s_mov_b32 s39, 15
  s_cmp_eq_u32 s12, 1
  s_cbranch_scc0 standalone__softmax_full_mha__prompt_kernel_np
  s_setprio 1
standalone__softmax_full_mha__prompt_kernel_np:
  v_mov_b32 v112, 0
  v_mov_b32 v113, 0
  v_mov_b32 v114, 0
  v_mov_b32 v115, 0
  v_mov_b32 v116, 0
  v_mov_b32 v117, 0
  v_mov_b32 v118, 0
  v_mov_b32 v119, 0
  v_mov_b32 v68, 0
  v_mov_b32 v69, 0
  v_mov_b32 v70, 0
  v_mov_b32 v71, 0
  s_cmp_eq_u32 s39, 0
  s_cbranch_scc1 standalone__softmax_full_mha__prompt_kernel_rdy1_oob
  s_andn2_b64 s[56:57], s[62:63], s[54:55]
  s_cbranch_scc1 standalone__softmax_full_mha__prompt_kernel_rdy1_ok
  s_mov_b32 s37, 0
standalone__softmax_full_mha__prompt_kernel_rdy1_p:
  buffer_load_dword v217, v216, s[28:31], s60 offen sc1
  s_waitcnt vmcnt(0)
  v_cmp_eq_u32 vcc, s48, v217
  s_add_u32 s37, s37, 1
  s_lshr_b64 s[62:63], vcc, s61
  s_and_b32 s62, s62, 0x11111111
  s_and_b32 s63, s63, 0x11111111
  s_cmp_gt_u32 s37, 200000
  s_cselect_b32 s36, 0x11111111, 0
  s_or_b32 s62, s62, s36
  s_or_b32 s63, s63, s36
  s_andn2_b64 s[56:57], s[62:63], s[54:55]
  s_cbranch_scc1 standalone__softmax_full_mha__prompt_kernel_rdy1_ok
  s_sleep 1
  s_branch standalone__softmax_full_mha__prompt_kernel_rdy1_p
standalone__softmax_full_mha__prompt_kernel_rdy1_ok:
  s_ff1_i32_b64 s36, s[56:57]
  s_bitset1_b64 s[54:55], s36
  s_lshl_b32 s38, s36, 12
  s_add_u32 s38, s38, s41
  s_sub_u32 s39, s39, 1
  s_branch standalone__softmax_full_mha__prompt_kernel_rdy1_e
standalone__softmax_full_mha__prompt_kernel_rdy1_oob:
  s_mov_b32 s38, 0x80000000
standalone__softmax_full_mha__prompt_kernel_rdy1_e:
  buffer_load_dwordx4 v[40:43], v1, s[28:31], s38 offen offset:0 sc1
  buffer_load_dwordx4 v[44:47], v1, s[28:31], s38 offen offset:1024 sc1
  buffer_load_dwordx4 v[56:59], v1, s[28:31], s38 offen offset:2048 sc1
  buffer_load_dwordx4 v[60:63], v1, s[28:31], s38 offen offset:3072 sc1
  s_cmp_ge_u32 s52, s13
  s_cbranch_scc1 standalone__softmax_full_mha__prompt_kernel_wp1_t
  s_mov_b32 m0, s53
  s_add_u32 s53, s53, 8192
  buffer_load_dwordx4 v210, s[20:23], s52 offen lds
  s_branch standalone__softmax_full_mha__prompt_kernel_wp1_e
standalone__softmax_full_mha__prompt_kernel_wp1_t:
  buffer_load_dword v211, v210, s[20:23], s52 offen
standalone__softmax_full_mha__prompt_kernel_wp1_e:
  s_add_u32 s52, s52, 131072
  s_cmp_eq_u32 s39, 0
  s_cbranch_scc1 standalone__softmax_full_mha__prompt_kernel_rdy2_oob
  s_andn2_b64 s[56:57], s[62:63], s[54:55]
  s_cbranch_scc1 standalone__softmax_full_mha__prompt_kernel_rdy2_ok
  s_mov_b32 s37, 0
standalone__softmax_full_mha__prompt_kernel_rdy2_p:
  buffer_load_dword v217, v216, s[28:31], s60 offen sc1
  s_waitcnt vmcnt(0)
  v_cmp_eq_u32 vcc, s48, v217
  s_add_u32 s37, s37, 1
  s_lshr_b64 s[62:63], vcc, s61
  s_and_b32 s62, s62, 0x11111111
  s_and_b32 s63, s63, 0x11111111
  s_cmp_gt_u32 s37, 200000
  s_cselect_b32 s36, 0x11111111, 0
  s_or_b32 s62, s62, s36
  s_or_b32 s63, s63, s36
  s_andn2_b64 s[56:57], s[62:63], s[54:55]
  s_cbranch_scc1 standalone__softmax_full_mha__prompt_kernel_rdy2_ok
  s_sleep 1
  s_branch standalone__softmax_full_mha__prompt_kernel_rdy2_p
standalone__softmax_full_mha__prompt_kernel_rdy2_ok:
  s_ff1_i32_b64 s36, s[56:57]
  s_bitset1_b64 s[54:55], s36
  s_lshl_b32 s38, s36, 12
  s_add_u32 s38, s38, s41
  s_sub_u32 s39, s39, 1
  s_branch standalone__softmax_full_mha__prompt_kernel_rdy2_e
standalone__softmax_full_mha__prompt_kernel_rdy2_oob:
  s_mov_b32 s38, 0x80000000
standalone__softmax_full_mha__prompt_kernel_rdy2_e:
  buffer_load_dwordx4 v[48:51], v1, s[28:31], s38 offen offset:0 sc1
  buffer_load_dwordx4 v[52:55], v1, s[28:31], s38 offen offset:1024 sc1
  buffer_load_dwordx4 v[64:67], v1, s[28:31], s38 offen offset:2048 sc1
  s_waitcnt vmcnt(6)
  v_mfma_f32_32x32x16_bf16 v[72:87], v[40:43], v[8:11], 0
  v_mfma_f32_32x32x16_bf16 v[72:87], v[44:47], v[12:15], v[72:87]
  s_mov_b32 s35, 0
  s_nop 15
standalone__softmax_full_mha__prompt_kernel_fast_loop:
  s_add_u32 s43, s35, 0
  s_cmp_ge_u32 s43, 12
  s_cbranch_scc0 standalone__softmax_full_mha__prompt_kernel_fast_sw0
  s_setprio 0
standalone__softmax_full_mha__prompt_kernel_fast_sw0:
  v_mfma_f32_32x32x16_bf16 v[88:103], v[40:43], v[16:19], 0
  v_exp_f32 v72, v72
  v_exp_f32 v73, v73
  v_exp_f32 v74, v74
  v_mfma_f32_32x32x16_bf16 v[88:103], v[44:47], v[20:23], v[88:103]
  v_exp_f32 v75, v75
  v_exp_f32 v76, v76
  v_exp_f32 v77, v77
  v_mfma_f32_32x32x16_bf16 v[168:183], v[68:71], v[116:119], v[168:183]
  buffer_load_dwordx4 v[68:71], v1, s[28:31], s38 offen offset:3072 sc1
  v_exp_f32 v78, v78
  v_exp_f32 v79, v79
  v_cvt_pk_bf16_f32 v104, v72, v73
  v_cvt_pk_bf16_f32 v105, v74, v75
  v_smfmac_f32_16x16x64_bf16 v[196:199], v[200:203], v[112:119], v204
  v_cvt_pk_bf16_f32 v106, v76, v77
  v_cvt_pk_bf16_f32 v107, v78, v79
  v_exp_f32 v80, v80
  v_exp_f32 v81, v81
  s_waitcnt vmcnt(6)
  v_mfma_f32_32x32x16_bf16 v[120:135], v[56:59], v[104:107], v[120:135]
  v_exp_f32 v82, v82
  v_exp_f32 v83, v83
  v_exp_f32 v84, v84
  v_exp_f32 v85, v85
  v_exp_f32 v86, v86
  v_exp_f32 v87, v87
  v_cvt_pk_bf16_f32 v108, v80, v81
  v_cvt_pk_bf16_f32 v109, v82, v83
  v_cvt_pk_bf16_f32 v110, v84, v85
  v_cvt_pk_bf16_f32 v111, v86, v87
  v_mfma_f32_32x32x16_bf16 v[72:87], v[40:43], v[24:27], 0
  v_exp_f32 v88, v88
  v_exp_f32 v89, v89
  v_exp_f32 v90, v90
  v_mfma_f32_32x32x16_bf16 v[72:87], v[44:47], v[28:31], v[72:87]
  v_exp_f32 v91, v91
  v_exp_f32 v92, v92
  v_exp_f32 v93, v93
  s_waitcnt vmcnt(5)
  v_mfma_f32_32x32x16_bf16 v[120:135], v[60:63], v[108:111], v[120:135]
  s_cmp_ge_u32 s52, s13
  s_cbranch_scc1 standalone__softmax_full_mha__prompt_kernel_wp2_t
  s_mov_b32 m0, s53
  s_add_u32 s53, s53, 8192
  buffer_load_dwordx4 v210, s[20:23], s52 offen lds
  s_branch standalone__softmax_full_mha__prompt_kernel_wp2_e
standalone__softmax_full_mha__prompt_kernel_wp2_t:
  buffer_load_dword v211, v210, s[20:23], s52 offen
standalone__softmax_full_mha__prompt_kernel_wp2_e:
  s_add_u32 s52, s52, 131072
  v_exp_f32 v94, v94
  v_exp_f32 v95, v95
  v_cvt_pk_bf16_f32 v112, v88, v89
  v_cvt_pk_bf16_f32 v113, v90, v91
  v_smfmac_f32_16x16x64_bf16 v[184:187], v[200:203], v[104:111], v204
  v_cvt_pk_bf16_f32 v114, v92, v93
  v_cvt_pk_bf16_f32 v115, v94, v95
  v_exp_f32 v96, v96
  v_exp_f32 v97, v97
  v_mfma_f32_32x32x16_bf16 v[136:151], v[56:59], v[112:115], v[136:151]
  v_exp_f32 v98, v98
  v_exp_f32 v99, v99
  v_exp_f32 v100, v100
  v_exp_f32 v101, v101
  v_exp_f32 v102, v102
  v_exp_f32 v103, v103
  v_cvt_pk_bf16_f32 v116, v96, v97
  v_cvt_pk_bf16_f32 v117, v98, v99
  v_cvt_pk_bf16_f32 v118, v100, v101
  v_cvt_pk_bf16_f32 v119, v102, v103
  v_mfma_f32_32x32x16_bf16 v[88:103], v[40:43], v[32:35], 0
  v_exp_f32 v72, v72
  v_exp_f32 v73, v73
  v_exp_f32 v74, v74
  v_mfma_f32_32x32x16_bf16 v[88:103], v[44:47], v[36:39], v[88:103]
  s_cmp_eq_u32 s39, 0
  s_cbranch_scc1 standalone__softmax_full_mha__prompt_kernel_rdy3_oob
  s_andn2_b64 s[56:57], s[62:63], s[54:55]
  s_cbranch_scc1 standalone__softmax_full_mha__prompt_kernel_rdy3_ok
  s_mov_b32 s37, 0
standalone__softmax_full_mha__prompt_kernel_rdy3_p:
  buffer_load_dword v217, v216, s[28:31], s60 offen sc1
  s_waitcnt vmcnt(0)
  v_cmp_eq_u32 vcc, s48, v217
  s_add_u32 s37, s37, 1
  s_lshr_b64 s[62:63], vcc, s61
  s_and_b32 s62, s62, 0x11111111
  s_and_b32 s63, s63, 0x11111111
  s_cmp_gt_u32 s37, 200000
  s_cselect_b32 s36, 0x11111111, 0
  s_or_b32 s62, s62, s36
  s_or_b32 s63, s63, s36
  s_andn2_b64 s[56:57], s[62:63], s[54:55]
  s_cbranch_scc1 standalone__softmax_full_mha__prompt_kernel_rdy3_ok
  s_sleep 1
  s_branch standalone__softmax_full_mha__prompt_kernel_rdy3_p
standalone__softmax_full_mha__prompt_kernel_rdy3_ok:
  s_ff1_i32_b64 s36, s[56:57]
  s_bitset1_b64 s[54:55], s36
  s_lshl_b32 s38, s36, 12
  s_add_u32 s38, s38, s41
  s_sub_u32 s39, s39, 1
  s_branch standalone__softmax_full_mha__prompt_kernel_rdy3_e
standalone__softmax_full_mha__prompt_kernel_rdy3_oob:
  s_mov_b32 s38, 0x80000000
standalone__softmax_full_mha__prompt_kernel_rdy3_e:
  buffer_load_dwordx4 v[40:43], v1, s[28:31], s38 offen offset:0 sc1
  buffer_load_dwordx4 v[44:47], v1, s[28:31], s38 offen offset:1024 sc1
  v_exp_f32 v75, v75
  v_exp_f32 v76, v76
  v_exp_f32 v77, v77
  v_mfma_f32_32x32x16_bf16 v[136:151], v[60:63], v[116:119], v[136:151]
  v_exp_f32 v78, v78
  v_exp_f32 v79, v79
  v_cvt_pk_bf16_f32 v104, v72, v73
  v_cvt_pk_bf16_f32 v105, v74, v75
  v_smfmac_f32_16x16x64_bf16 v[188:191], v[200:203], v[112:119], v204
  v_cvt_pk_bf16_f32 v106, v76, v77
  v_cvt_pk_bf16_f32 v107, v78, v79
  v_exp_f32 v80, v80
  v_exp_f32 v81, v81
  v_mfma_f32_32x32x16_bf16 v[152:167], v[56:59], v[104:107], v[152:167]
  v_exp_f32 v82, v82
  v_exp_f32 v83, v83
  v_exp_f32 v84, v84
  v_exp_f32 v85, v85
  v_exp_f32 v86, v86
  v_exp_f32 v87, v87
  v_cvt_pk_bf16_f32 v108, v80, v81
  v_cvt_pk_bf16_f32 v109, v82, v83
  v_cvt_pk_bf16_f32 v110, v84, v85
  v_cvt_pk_bf16_f32 v111, v86, v87
  s_waitcnt vmcnt(5)
  v_mfma_f32_32x32x16_bf16 v[72:87], v[48:51], v[8:11], 0
  v_exp_f32 v88, v88
  v_exp_f32 v89, v89
  v_exp_f32 v90, v90
  v_mfma_f32_32x32x16_bf16 v[72:87], v[52:55], v[12:15], v[72:87]
  v_exp_f32 v91, v91
  v_exp_f32 v92, v92
  v_exp_f32 v93, v93
  v_mfma_f32_32x32x16_bf16 v[152:167], v[60:63], v[108:111], v[152:167]
  v_exp_f32 v94, v94
  v_exp_f32 v95, v95
  v_cvt_pk_bf16_f32 v112, v88, v89
  v_cvt_pk_bf16_f32 v113, v90, v91
  v_smfmac_f32_16x16x64_bf16 v[192:195], v[200:203], v[104:111], v204
  v_cvt_pk_bf16_f32 v114, v92, v93
  v_cvt_pk_bf16_f32 v115, v94, v95
  v_exp_f32 v96, v96
  v_exp_f32 v97, v97
  v_mfma_f32_32x32x16_bf16 v[168:183], v[56:59], v[112:115], v[168:183]
  buffer_load_dwordx4 v[56:59], v1, s[28:31], s38 offen offset:2048 sc1
  v_exp_f32 v98, v98
  v_exp_f32 v99, v99
  v_exp_f32 v100, v100
  v_exp_f32 v101, v101
  v_exp_f32 v102, v102
  v_exp_f32 v103, v103
  v_cvt_pk_bf16_f32 v116, v96, v97
  v_cvt_pk_bf16_f32 v117, v98, v99
  v_cvt_pk_bf16_f32 v118, v100, v101
  v_cvt_pk_bf16_f32 v119, v102, v103
  s_add_u32 s43, s35, 1
  s_cmp_ge_u32 s43, 12
  s_cbranch_scc0 standalone__softmax_full_mha__prompt_kernel_fast_sw4
  s_setprio 0
standalone__softmax_full_mha__prompt_kernel_fast_sw4:
  v_mfma_f32_32x32x16_bf16 v[88:103], v[48:51], v[16:19], 0
  v_exp_f32 v72, v72
  v_exp_f32 v73, v73
  v_exp_f32 v74, v74
  v_mfma_f32_32x32x16_bf16 v[88:103], v[52:55], v[20:23], v[88:103]
  v_exp_f32 v75, v75
  v_exp_f32 v76, v76
  v_exp_f32 v77, v77
  v_mfma_f32_32x32x16_bf16 v[168:183], v[60:63], v[116:119], v[168:183]
  buffer_load_dwordx4 v[60:63], v1, s[28:31], s38 offen offset:3072 sc1
  v_exp_f32 v78, v78
  v_exp_f32 v79, v79
  v_cvt_pk_bf16_f32 v104, v72, v73
  v_cvt_pk_bf16_f32 v105, v74, v75
  v_smfmac_f32_16x16x64_bf16 v[196:199], v[200:203], v[112:119], v204
  v_cvt_pk_bf16_f32 v106, v76, v77
  v_cvt_pk_bf16_f32 v107, v78, v79
  v_exp_f32 v80, v80
  v_exp_f32 v81, v81
  s_waitcnt vmcnt(6)
  v_mfma_f32_32x32x16_bf16 v[120:135], v[64:67], v[104:107], v[120:135]
  v_exp_f32 v82, v82
  v_exp_f32 v83, v83
  v_exp_f32 v84, v84
  v_exp_f32 v85, v85
  v_exp_f32 v86, v86
  v_exp_f32 v87, v87
  v_cvt_pk_bf16_f32 v108, v80, v81
  v_cvt_pk_bf16_f32 v109, v82, v83
  v_cvt_pk_bf16_f32 v110, v84, v85
  v_cvt_pk_bf16_f32 v111, v86, v87
  v_mfma_f32_32x32x16_bf16 v[72:87], v[48:51], v[24:27], 0
  v_exp_f32 v88, v88
  v_exp_f32 v89, v89
  v_exp_f32 v90, v90
  v_mfma_f32_32x32x16_bf16 v[72:87], v[52:55], v[28:31], v[72:87]
  v_exp_f32 v91, v91
  v_exp_f32 v92, v92
  v_exp_f32 v93, v93
  s_waitcnt vmcnt(5)
  v_mfma_f32_32x32x16_bf16 v[120:135], v[68:71], v[108:111], v[120:135]
  s_cmp_ge_u32 s52, s13
  s_cbranch_scc1 standalone__softmax_full_mha__prompt_kernel_wp3_t
  s_mov_b32 m0, s53
  s_add_u32 s53, s53, 8192
  buffer_load_dwordx4 v210, s[20:23], s52 offen lds
  s_branch standalone__softmax_full_mha__prompt_kernel_wp3_e
standalone__softmax_full_mha__prompt_kernel_wp3_t:
  buffer_load_dword v211, v210, s[20:23], s52 offen
standalone__softmax_full_mha__prompt_kernel_wp3_e:
  s_add_u32 s52, s52, 131072
  v_exp_f32 v94, v94
  v_exp_f32 v95, v95
  v_cvt_pk_bf16_f32 v112, v88, v89
  v_cvt_pk_bf16_f32 v113, v90, v91
  v_smfmac_f32_16x16x64_bf16 v[184:187], v[200:203], v[104:111], v204
  v_cvt_pk_bf16_f32 v114, v92, v93
  v_cvt_pk_bf16_f32 v115, v94, v95
  v_exp_f32 v96, v96
  v_exp_f32 v97, v97
  v_mfma_f32_32x32x16_bf16 v[136:151], v[64:67], v[112:115], v[136:151]
  v_exp_f32 v98, v98
  v_exp_f32 v99, v99
  v_exp_f32 v100, v100
  v_exp_f32 v101, v101
  v_exp_f32 v102, v102
  v_exp_f32 v103, v103
  v_cvt_pk_bf16_f32 v116, v96, v97
  v_cvt_pk_bf16_f32 v117, v98, v99
  v_cvt_pk_bf16_f32 v118, v100, v101
  v_cvt_pk_bf16_f32 v119, v102, v103
  v_mfma_f32_32x32x16_bf16 v[88:103], v[48:51], v[32:35], 0
  v_exp_f32 v72, v72
  v_exp_f32 v73, v73
  v_exp_f32 v74, v74
  v_mfma_f32_32x32x16_bf16 v[88:103], v[52:55], v[36:39], v[88:103]
  s_cmp_eq_u32 s39, 0
  s_cbranch_scc1 standalone__softmax_full_mha__prompt_kernel_rdy4_oob
  s_andn2_b64 s[56:57], s[62:63], s[54:55]
  s_cbranch_scc1 standalone__softmax_full_mha__prompt_kernel_rdy4_ok
  s_mov_b32 s37, 0
standalone__softmax_full_mha__prompt_kernel_rdy4_p:
  buffer_load_dword v217, v216, s[28:31], s60 offen sc1
  s_waitcnt vmcnt(0)
  v_cmp_eq_u32 vcc, s48, v217
  s_add_u32 s37, s37, 1
  s_lshr_b64 s[62:63], vcc, s61
  s_and_b32 s62, s62, 0x11111111
  s_and_b32 s63, s63, 0x11111111
  s_cmp_gt_u32 s37, 200000
  s_cselect_b32 s36, 0x11111111, 0
  s_or_b32 s62, s62, s36
  s_or_b32 s63, s63, s36
  s_andn2_b64 s[56:57], s[62:63], s[54:55]
  s_cbranch_scc1 standalone__softmax_full_mha__prompt_kernel_rdy4_ok
  s_sleep 1
  s_branch standalone__softmax_full_mha__prompt_kernel_rdy4_p
standalone__softmax_full_mha__prompt_kernel_rdy4_ok:
  s_ff1_i32_b64 s36, s[56:57]
  s_bitset1_b64 s[54:55], s36
  s_lshl_b32 s38, s36, 12
  s_add_u32 s38, s38, s41
  s_sub_u32 s39, s39, 1
  s_branch standalone__softmax_full_mha__prompt_kernel_rdy4_e
standalone__softmax_full_mha__prompt_kernel_rdy4_oob:
  s_mov_b32 s38, 0x80000000
standalone__softmax_full_mha__prompt_kernel_rdy4_e:
  buffer_load_dwordx4 v[48:51], v1, s[28:31], s38 offen offset:0 sc1
  buffer_load_dwordx4 v[52:55], v1, s[28:31], s38 offen offset:1024 sc1
  v_exp_f32 v75, v75
  v_exp_f32 v76, v76
  v_exp_f32 v77, v77
  v_mfma_f32_32x32x16_bf16 v[136:151], v[68:71], v[116:119], v[136:151]
  v_exp_f32 v78, v78
  v_exp_f32 v79, v79
  v_cvt_pk_bf16_f32 v104, v72, v73
  v_cvt_pk_bf16_f32 v105, v74, v75
  v_smfmac_f32_16x16x64_bf16 v[188:191], v[200:203], v[112:119], v204
  v_cvt_pk_bf16_f32 v106, v76, v77
  v_cvt_pk_bf16_f32 v107, v78, v79
  v_exp_f32 v80, v80
  v_exp_f32 v81, v81
  v_mfma_f32_32x32x16_bf16 v[152:167], v[64:67], v[104:107], v[152:167]
  v_exp_f32 v82, v82
  v_exp_f32 v83, v83
  v_exp_f32 v84, v84
  v_exp_f32 v85, v85
  v_exp_f32 v86, v86
  v_exp_f32 v87, v87
  v_cvt_pk_bf16_f32 v108, v80, v81
  v_cvt_pk_bf16_f32 v109, v82, v83
  v_cvt_pk_bf16_f32 v110, v84, v85
  v_cvt_pk_bf16_f32 v111, v86, v87
  s_waitcnt vmcnt(5)
  v_mfma_f32_32x32x16_bf16 v[72:87], v[40:43], v[8:11], 0
  v_exp_f32 v88, v88
  v_exp_f32 v89, v89
  v_exp_f32 v90, v90
  v_mfma_f32_32x32x16_bf16 v[72:87], v[44:47], v[12:15], v[72:87]
  v_exp_f32 v91, v91
  v_exp_f32 v92, v92
  v_exp_f32 v93, v93
  v_mfma_f32_32x32x16_bf16 v[152:167], v[68:71], v[108:111], v[152:167]
  v_exp_f32 v94, v94
  v_exp_f32 v95, v95
  v_cvt_pk_bf16_f32 v112, v88, v89
  v_cvt_pk_bf16_f32 v113, v90, v91
  v_smfmac_f32_16x16x64_bf16 v[192:195], v[200:203], v[104:111], v204
  v_cvt_pk_bf16_f32 v114, v92, v93
  v_cvt_pk_bf16_f32 v115, v94, v95
  v_exp_f32 v96, v96
  v_exp_f32 v97, v97
  v_mfma_f32_32x32x16_bf16 v[168:183], v[64:67], v[112:115], v[168:183]
  buffer_load_dwordx4 v[64:67], v1, s[28:31], s38 offen offset:2048 sc1
  v_exp_f32 v98, v98
  v_exp_f32 v99, v99
  v_exp_f32 v100, v100
  v_exp_f32 v101, v101
  v_exp_f32 v102, v102
  v_exp_f32 v103, v103
  v_cvt_pk_bf16_f32 v116, v96, v97
  v_cvt_pk_bf16_f32 v117, v98, v99
  v_cvt_pk_bf16_f32 v118, v100, v101
  v_cvt_pk_bf16_f32 v119, v102, v103
  s_add_u32 s35, s35, 2
  s_cmp_lt_u32 s35, 14
  s_cbranch_scc1 standalone__softmax_full_mha__prompt_kernel_fast_loop
  buffer_load_dwordx4 v[212:215], v216, s[28:31], s15 offen sc1
  v_mfma_f32_32x32x16_bf16 v[88:103], v[40:43], v[16:19], 0
  v_exp_f32 v72, v72
  v_exp_f32 v73, v73
  v_exp_f32 v74, v74
  v_mfma_f32_32x32x16_bf16 v[88:103], v[44:47], v[20:23], v[88:103]
  v_exp_f32 v75, v75
  v_exp_f32 v76, v76
  v_exp_f32 v77, v77
  v_mfma_f32_32x32x16_bf16 v[168:183], v[68:71], v[116:119], v[168:183]
  buffer_load_dwordx4 v[68:71], v1, s[28:31], s38 offen offset:3072 sc1
  v_exp_f32 v78, v78
  v_exp_f32 v79, v79
  v_cvt_pk_bf16_f32 v104, v72, v73
  v_cvt_pk_bf16_f32 v105, v74, v75
  v_smfmac_f32_16x16x64_bf16 v[196:199], v[200:203], v[112:119], v204
  v_cvt_pk_bf16_f32 v106, v76, v77
  v_cvt_pk_bf16_f32 v107, v78, v79
  v_exp_f32 v80, v80
  v_exp_f32 v81, v81
  s_waitcnt vmcnt(6)
  v_mfma_f32_32x32x16_bf16 v[120:135], v[56:59], v[104:107], v[120:135]
  v_exp_f32 v82, v82
  v_exp_f32 v83, v83
  v_exp_f32 v84, v84
  v_exp_f32 v85, v85
  v_exp_f32 v86, v86
  v_exp_f32 v87, v87
  v_cvt_pk_bf16_f32 v108, v80, v81
  v_cvt_pk_bf16_f32 v109, v82, v83
  v_cvt_pk_bf16_f32 v110, v84, v85
  v_cvt_pk_bf16_f32 v111, v86, v87
  v_mfma_f32_32x32x16_bf16 v[72:87], v[40:43], v[24:27], 0
  v_exp_f32 v88, v88
  v_exp_f32 v89, v89
  v_exp_f32 v90, v90
  v_mfma_f32_32x32x16_bf16 v[72:87], v[44:47], v[28:31], v[72:87]
  v_exp_f32 v91, v91
  v_exp_f32 v92, v92
  v_exp_f32 v93, v93
  s_waitcnt vmcnt(5)
  v_mfma_f32_32x32x16_bf16 v[120:135], v[60:63], v[108:111], v[120:135]
  s_cmp_ge_u32 s52, s13
  s_cbranch_scc1 standalone__softmax_full_mha__prompt_kernel_wp4_t
  s_mov_b32 m0, s53
  s_add_u32 s53, s53, 8192
  buffer_load_dwordx4 v210, s[20:23], s52 offen lds
  s_branch standalone__softmax_full_mha__prompt_kernel_wp4_e
standalone__softmax_full_mha__prompt_kernel_wp4_t:
  buffer_load_dword v211, v210, s[20:23], s52 offen
standalone__softmax_full_mha__prompt_kernel_wp4_e:
  s_add_u32 s52, s52, 131072
  v_exp_f32 v94, v94
  v_exp_f32 v95, v95
  v_cvt_pk_bf16_f32 v112, v88, v89
  v_cvt_pk_bf16_f32 v113, v90, v91
  v_smfmac_f32_16x16x64_bf16 v[184:187], v[200:203], v[104:111], v204
  v_cvt_pk_bf16_f32 v114, v92, v93
  v_cvt_pk_bf16_f32 v115, v94, v95
  v_exp_f32 v96, v96
  v_exp_f32 v97, v97
  v_mfma_f32_32x32x16_bf16 v[136:151], v[56:59], v[112:115], v[136:151]
  v_exp_f32 v98, v98
  v_exp_f32 v99, v99
  v_exp_f32 v100, v100
  v_exp_f32 v101, v101
  v_exp_f32 v102, v102
  v_exp_f32 v103, v103
  v_cvt_pk_bf16_f32 v116, v96, v97
  v_cvt_pk_bf16_f32 v117, v98, v99
  v_cvt_pk_bf16_f32 v118, v100, v101
  v_cvt_pk_bf16_f32 v119, v102, v103
  v_mfma_f32_32x32x16_bf16 v[88:103], v[40:43], v[32:35], 0
  v_exp_f32 v72, v72
  v_exp_f32 v73, v73
  v_exp_f32 v74, v74
  v_mfma_f32_32x32x16_bf16 v[88:103], v[44:47], v[36:39], v[88:103]
  s_cmp_eq_u32 s39, 0
  s_cbranch_scc1 standalone__softmax_full_mha__prompt_kernel_rdy5_oob
  s_andn2_b64 s[56:57], s[62:63], s[54:55]
  s_cbranch_scc1 standalone__softmax_full_mha__prompt_kernel_rdy5_ok
  s_mov_b32 s37, 0
standalone__softmax_full_mha__prompt_kernel_rdy5_p:
  buffer_load_dword v217, v216, s[28:31], s60 offen sc1
  s_waitcnt vmcnt(0)
  v_cmp_eq_u32 vcc, s48, v217
  s_add_u32 s37, s37, 1
  s_lshr_b64 s[62:63], vcc, s61
  s_and_b32 s62, s62, 0x11111111
  s_and_b32 s63, s63, 0x11111111
  s_cmp_gt_u32 s37, 200000
  s_cselect_b32 s36, 0x11111111, 0
  s_or_b32 s62, s62, s36
  s_or_b32 s63, s63, s36
  s_andn2_b64 s[56:57], s[62:63], s[54:55]
  s_cbranch_scc1 standalone__softmax_full_mha__prompt_kernel_rdy5_ok
  s_sleep 1
  s_branch standalone__softmax_full_mha__prompt_kernel_rdy5_p
standalone__softmax_full_mha__prompt_kernel_rdy5_ok:
  s_ff1_i32_b64 s36, s[56:57]
  s_bitset1_b64 s[54:55], s36
  s_lshl_b32 s38, s36, 12
  s_add_u32 s38, s38, s41
  s_sub_u32 s39, s39, 1
  s_branch standalone__softmax_full_mha__prompt_kernel_rdy5_e
standalone__softmax_full_mha__prompt_kernel_rdy5_oob:
  s_mov_b32 s38, 0x80000000
standalone__softmax_full_mha__prompt_kernel_rdy5_e:
  buffer_load_dwordx4 v[40:43], v1, s[28:31], s38 offen offset:0 sc1
  buffer_load_dwordx4 v[44:47], v1, s[28:31], s38 offen offset:1024 sc1
  v_exp_f32 v75, v75
  v_exp_f32 v76, v76
  v_exp_f32 v77, v77
  v_mfma_f32_32x32x16_bf16 v[136:151], v[60:63], v[116:119], v[136:151]
  v_exp_f32 v78, v78
  v_exp_f32 v79, v79
  v_cvt_pk_bf16_f32 v104, v72, v73
  v_cvt_pk_bf16_f32 v105, v74, v75
  v_smfmac_f32_16x16x64_bf16 v[188:191], v[200:203], v[112:119], v204
  v_cvt_pk_bf16_f32 v106, v76, v77
  v_cvt_pk_bf16_f32 v107, v78, v79
  v_exp_f32 v80, v80
  v_exp_f32 v81, v81
  v_mfma_f32_32x32x16_bf16 v[152:167], v[56:59], v[104:107], v[152:167]
  v_exp_f32 v82, v82
  v_exp_f32 v83, v83
  v_exp_f32 v84, v84
  v_exp_f32 v85, v85
  v_exp_f32 v86, v86
  v_exp_f32 v87, v87
  v_cvt_pk_bf16_f32 v108, v80, v81
  v_cvt_pk_bf16_f32 v109, v82, v83
  v_cvt_pk_bf16_f32 v110, v84, v85
  v_cvt_pk_bf16_f32 v111, v86, v87
  v_add_f32 v184, v184, v185
  ds_write_b128 v219, v[120:123] offset:0
  ds_write_b128 v219, v[124:127] offset:1024
  ds_write_b128 v219, v[128:131] offset:2048
  ds_write_b128 v219, v[132:135] offset:3072
  ds_write_b32 v222, v184 offset:4096
  v_exp_f32 v88, v88
  v_exp_f32 v89, v89
  v_exp_f32 v90, v90
  v_exp_f32 v91, v91
  v_exp_f32 v92, v92
  v_exp_f32 v93, v93
  v_mfma_f32_32x32x16_bf16 v[152:167], v[60:63], v[108:111], v[152:167]
  v_exp_f32 v94, v94
  v_exp_f32 v95, v95
  v_cvt_pk_bf16_f32 v112, v88, v89
  v_cvt_pk_bf16_f32 v113, v90, v91
  v_smfmac_f32_16x16x64_bf16 v[192:195], v[200:203], v[104:111], v204
  v_cvt_pk_bf16_f32 v114, v92, v93
  v_cvt_pk_bf16_f32 v115, v94, v95
  v_exp_f32 v96, v96
  v_exp_f32 v97, v97
  v_mfma_f32_32x32x16_bf16 v[168:183], v[56:59], v[112:115], v[168:183]
  buffer_load_dwordx4 v[56:59], v1, s[28:31], s38 offen offset:2048 sc1
  v_exp_f32 v98, v98
  v_exp_f32 v99, v99
  v_exp_f32 v100, v100
  v_exp_f32 v101, v101
  v_exp_f32 v102, v102
  v_exp_f32 v103, v103
  v_cvt_pk_bf16_f32 v116, v96, v97
  v_cvt_pk_bf16_f32 v117, v98, v99
  v_cvt_pk_bf16_f32 v118, v100, v101
  v_cvt_pk_bf16_f32 v119, v102, v103
  v_add_f32 v188, v188, v189
  ds_write_b128 v220, v[136:139] offset:0
  ds_write_b128 v220, v[140:143] offset:1024
  ds_write_b128 v220, v[144:147] offset:2048
  ds_write_b128 v220, v[148:151] offset:3072
  ds_write_b32 v223, v188 offset:4096
  s_nop 1
  v_mfma_f32_32x32x16_bf16 v[168:183], v[60:63], v[116:119], v[168:183]
  v_smfmac_f32_16x16x64_bf16 v[196:199], v[200:203], v[112:119], v204
  s_setprio 0
  s_mov_b32 s37, 0
standalone__softmax_full_mha__prompt_kernel_chk:
  s_waitcnt vmcnt(0)
  v_cmp_eq_u32 vcc, s48, v212
  s_add_u32 s37, s37, 1
  s_cmp_eq_u64 vcc, -1
  s_cbranch_scc1 standalone__softmax_full_mha__prompt_kernel_chkgot
  s_cmp_gt_u32 s37, 200000
  s_cbranch_scc1 standalone__softmax_full_mha__prompt_kernel_chkgot
  buffer_load_dwordx4 v[212:215], v216, s[28:31], s15 offen sc1
  s_sleep 1
  s_branch standalone__softmax_full_mha__prompt_kernel_chk
standalone__softmax_full_mha__prompt_kernel_chkgot:
  v_and_b32 v2, 3, v0
  v_lshlrev_b32 v2, 2, v2
  ds_read_b32 v4, v2 offset:57344
  s_waitcnt lgkmcnt(0)
  v_max_f32_dpp v4, v4, v4 quad_perm:[1,0,3,2] row_mask:0xf bank_mask:0xf
  s_nop 1
  v_max_f32_dpp v4, v4, v4 quad_perm:[2,3,0,1] row_mask:0xf bank_mask:0xf
  s_nop 1
  v_readfirstlane_b32 s49, v4
  s_nop 1
  v_mul_f32 v2, s49, v213
  v_mov_b32 v3, 1158676480
  v_cmp_le_f32 vcc, v2, v3
  v_mov_b32 v3, 1904214016
  v_cmp_le_f32 s[56:57], v214, v3
  v_mov_b32 v3, 226492416
  v_cmp_ge_f32 s[58:59], v214, v3
  s_nop 1
  s_and_b64 s[56:57], s[56:57], vcc
  s_and_b64 s[56:57], s[56:57], s[58:59]
  s_cmp_eq_u64 s[56:57], -1
  s_cselect_b32 s43, 1, 0
  s_cmp_eq_u32 s43, 0
  s_cbranch_scc1 standalone__softmax_full_mha__prompt_kernel_slow
standalone__softmax_full_mha__prompt_kernel_fin:
  s_nop 15
  v_add_f32 v192, v192, v193
  ds_write_b128 v221, v[152:155] offset:0
  ds_write_b128 v221, v[156:159] offset:1024
  ds_write_b128 v221, v[160:163] offset:2048
  ds_write_b128 v221, v[164:167] offset:3072
  ds_write_b32 v224, v192 offset:4096
  v_add_f32 v196, v196, v197
  s_waitcnt lgkmcnt(0)
  s_barrier
  s_lshl_b32 s36, s12, 2
  s_add_u32 s36, s36, s19
  s_mul_i32 s36, s36, 13056
  s_add_u32 s36, s36, 59392
  v_add_u32 v2, s36, v1
  v_lshrrev_b32 v3, 2, v1
  v_add_u32 v3, s36, v3
  ds_read_b128 v[72:75], v2 offset:0
  ds_read_b128 v[76:79], v2 offset:1024
  ds_read_b128 v[80:83], v2 offset:2048
  ds_read_b128 v[84:87], v2 offset:3072
  ds_read_b32 v104, v3 offset:4096
  ds_read_b128 v[88:91], v2 offset:4352
  ds_read_b128 v[92:95], v2 offset:5376
  ds_read_b128 v[96:99], v2 offset:6400
  ds_read_b128 v[100:103], v2 offset:7424
  ds_read_b32 v105, v3 offset:8448
  ds_read_b128 v[40:43], v2 offset:8704
  ds_read_b128 v[44:47], v2 offset:9728
  ds_read_b128 v[48:51], v2 offset:10752
  ds_read_b128 v[52:55], v2 offset:11776
  ds_read_b32 v106, v3 offset:12800
  s_waitcnt lgkmcnt(0)
  v_add_f32 v104, v104, v105
  v_add_f32 v106, v106, v196
  v_add_f32 v104, v104, v106
  v_rcp_f32 v112, v104
  v_add_f32 v72, v72, v88
  v_add_f32 v40, v40, v168
  v_add_f32 v73, v73, v89
  v_add_f32 v41, v41, v169
  v_add_f32 v74, v74, v90
  v_add_f32 v42, v42, v170
  v_add_f32 v75, v75, v91
  v_add_f32 v43, v43, v171
  v_add_f32 v76, v76, v92
  v_add_f32 v44, v44, v172
  v_add_f32 v77, v77, v93
  v_add_f32 v45, v45, v173
  v_add_f32 v78, v78, v94
  v_add_f32 v46, v46, v174
  v_add_f32 v79, v79, v95
  v_add_f32 v47, v47, v175
  v_add_f32 v80, v80, v96
  v_add_f32 v48, v48, v176
  v_add_f32 v81, v81, v97
  v_add_f32 v49, v49, v177
  v_add_f32 v82, v82, v98
  v_add_f32 v50, v50, v178
  v_add_f32 v83, v83, v99
  v_add_f32 v51, v51, v179
  v_add_f32 v84, v84, v100
  v_add_f32 v52, v52, v180
  v_add_f32 v85, v85, v101
  v_add_f32 v53, v53, v181
  v_add_f32 v86, v86, v102
  v_add_f32 v54, v54, v182
  v_add_f32 v87, v87, v103
  v_add_f32 v55, v55, v183
  v_add_f32 v72, v72, v40
  v_add_f32 v73, v73, v41
  v_add_f32 v74, v74, v42
  v_add_f32 v75, v75, v43
  v_add_f32 v76, v76, v44
  v_add_f32 v77, v77, v45
  v_add_f32 v78, v78, v46
  v_add_f32 v79, v79, v47
  v_add_f32 v80, v80, v48
  v_add_f32 v81, v81, v49
  v_add_f32 v82, v82, v50
  v_add_f32 v83, v83, v51
  v_add_f32 v84, v84, v52
  v_add_f32 v85, v85, v53
  v_add_f32 v86, v86, v54
  v_add_f32 v87, v87, v55
  v_mul_f32 v72, v72, v112
  v_mul_f32 v73, v73, v112
  v_mul_f32 v74, v74, v112
  v_mul_f32 v75, v75, v112
  v_mul_f32 v76, v76, v112
  v_mul_f32 v77, v77, v112
  v_mul_f32 v78, v78, v112
  v_mul_f32 v79, v79, v112
  v_mul_f32 v80, v80, v112
  v_mul_f32 v81, v81, v112
  v_mul_f32 v82, v82, v112
  v_mul_f32 v83, v83, v112
  v_mul_f32 v84, v84, v112
  v_mul_f32 v85, v85, v112
  v_mul_f32 v86, v86, v112
  v_mul_f32 v87, v87, v112
  v_cvt_pk_bf16_f32 v104, v72, v73
  v_cvt_pk_bf16_f32 v105, v74, v75
  v_cvt_pk_bf16_f32 v106, v76, v77
  v_cvt_pk_bf16_f32 v107, v78, v79
  v_cvt_pk_bf16_f32 v108, v80, v81
  v_cvt_pk_bf16_f32 v109, v82, v83
  v_cvt_pk_bf16_f32 v110, v84, v85
  v_cvt_pk_bf16_f32 v111, v86, v87
  s_lshl_b32 s36, s16, 2
  s_add_u32 s36, s36, s19
  s_lshl_b32 s36, s36, 6
  s_add_u32 s36, s36, s14
  s_lshl_b32 s36, s36, 10
  s_add_u32 s36, s36, 12582912
  v_bfe_u32 v2, v0, 4, 1
  v_lshlrev_b32 v2, 15, v2
  v_lshrrev_b32 v3, 5, v0
  v_lshl_add_u32 v2, v3, 8, v2
  v_and_b32 v3, 15, v0
  v_lshl_add_u32 v2, v3, 4, v2
  buffer_store_dwordx4 v[104:107], v2, s[28:31], s36 offen offset:0 sc1
  buffer_store_dwordx4 v[108:111], v2, s[28:31], s36 offen offset:512 sc1
  s_waitcnt vmcnt(0)
  s_lshl_b32 s36, s16, 4
  s_add_u32 s36, s36, s17
  s_lshl_b32 s36, s36, 3
  s_add_u32 s36, s36, s18
  s_lshl_b32 s36, s36, 7
  s_add_u32 s36, s36, 17956864
  v_mov_b32 v2, 0
  v_mov_b32 v3, s48
  s_mov_b64 exec, 1
  buffer_store_dword v3, v2, s[28:31], s36 offen sc1
  s_mov_b64 exec, -1
  s_barrier
  s_lshl_b32 s52, s18, 14
  s_lshl_b32 s53, s18, 10
  s_add_u32 s52, s52, 917504
  s_add_u32 s53, s53, 57344
  s_mov_b32 m0, s53
  s_add_u32 s53, s53, 8192
  buffer_load_dwordx4 v210, s[20:23], s52 offen lds
  s_add_u32 s52, s52, 131072
  s_mov_b32 m0, s53
  s_add_u32 s53, s53, 8192
  buffer_load_dwordx4 v210, s[20:23], s52 offen lds
  s_add_u32 s52, s52, 131072
  s_mov_b32 m0, s53
  s_add_u32 s53, s53, 8192
  buffer_load_dwordx4 v210, s[20:23], s52 offen lds
  s_add_u32 s52, s52, 131072
  s_mov_b32 m0, s53
  s_add_u32 s53, s53, 8192
  buffer_load_dwordx4 v210, s[20:23], s52 offen lds
  s_add_u32 s52, s52, 131072
  s_mov_b32 m0, s53
  s_add_u32 s53, s53, 8192
  buffer_load_dwordx4 v210, s[20:23], s52 offen lds
  s_add_u32 s52, s52, 131072
  s_mov_b32 m0, s53
  s_add_u32 s53, s53, 8192
  buffer_load_dwordx4 v210, s[20:23], s52 offen lds
  s_add_u32 s52, s52, 131072
  s_mov_b32 m0, s53
  s_add_u32 s53, s53, 8192
  buffer_load_dwordx4 v210, s[20:23], s52 offen lds
  s_add_u32 s52, s52, 131072
  s_mov_b32 m0, s53
  s_add_u32 s53, s53, 8192
  buffer_load_dwordx4 v210, s[20:23], s52 offen lds
  s_add_u32 s52, s52, 131072
  s_mov_b32 m0, s53
  s_add_u32 s53, s53, 8192
  buffer_load_dwordx4 v210, s[20:23], s52 offen lds
  s_add_u32 s52, s52, 131072
  v_and_b32 v2, 31, v0
  v_lshrrev_b32 v3, 1, v2
  v_lshlrev_b32 v3, 3, v3
  v_and_b32 v2, 1, v2
  v_lshl_add_u32 v3, v2, 2, v3
  v_lshlrev_b32 v4, 7, v3
  s_lshl_b32 s36, s50, 7
  s_lshr_b32 s37, s18, 1
  s_add_u32 s36, s36, s37
  s_lshl_b32 s36, s36, 7
  s_add_u32 s36, s36, 17956864
  v_mov_b32 v8, 0
  v_mov_b32 v9, 0
  v_mov_b32 v10, 0
  v_mov_b32 v11, 0
  v_mov_b32 v12, 0
  v_mov_b32 v13, 0
  v_mov_b32 v14, 0
  v_mov_b32 v15, 0
  v_mov_b32 v16, 0
  v_mov_b32 v17, 0
  v_mov_b32 v18, 0
  v_mov_b32 v19, 0
  v_mov_b32 v20, 0
  v_mov_b32 v21, 0
  v_mov_b32 v22, 0
  v_mov_b32 v23, 0
  s_mov_b32 s40, s36
  s_lshl_b32 s36, s50, 3
  s_add_u32 s36, s36, s18
  s_lshl_b32 s38, s36, 15
  s_add_u32 s38, s38, 12582912
  s_mov_b32 s41, 0
  s_mov_b32 s43, 0
  s_mov_b32 s39, 0
  s_waitcnt vmcnt(0)
  buffer_load_dword v5, v4, s[28:31], s40 offen sc1
  s_barrier
  s_lshl_b32 s36, s18, 14
  v_subrev_u32 v56, s36, v234
  v_add_u32 v60, 0x10000, v56
  v_subrev_u32 v57, s36, v235
  v_add_u32 v61, 0x10000, v57
  v_subrev_u32 v58, s36, v236
  v_add_u32 v62, 0x10000, v58
  v_subrev_u32 v59, s36, v237
  v_add_u32 v63, 0x10000, v59
standalone__softmax_full_mha__prompt_kernel_opoll:
  s_waitcnt vmcnt(0)
  v_cmp_eq_u32 vcc, s48, v5
  s_add_u32 s39, s39, 1
  s_cmp_eq_u64 vcc, -1
  s_cbranch_scc1 standalone__softmax_full_mha__prompt_kernel_ogot
  s_cmp_gt_u32 s39, 200000
  s_cbranch_scc1 standalone__softmax_full_mha__prompt_kernel_ogot
  s_sleep 1
  buffer_load_dword v5, v4, s[28:31], s40 offen sc1
  s_branch standalone__softmax_full_mha__prompt_kernel_opoll
standalone__softmax_full_mha__prompt_kernel_ogot:
  buffer_load_dwordx4 v[64:67], v1, s[28:31], s38 offen offset:0 sc1
  buffer_load_dwordx4 v[68:71], v1, s[28:31], s38 offen offset:1024 sc1
  buffer_load_dwordx4 v[72:75], v1, s[28:31], s38 offen offset:2048 sc1
  buffer_load_dwordx4 v[76:79], v1, s[28:31], s38 offen offset:3072 sc1
  s_add_u32 s38, s38, 4096
  buffer_load_dwordx4 v[80:83], v1, s[28:31], s38 offen offset:0 sc1
  buffer_load_dwordx4 v[84:87], v1, s[28:31], s38 offen offset:1024 sc1
  buffer_load_dwordx4 v[88:91], v1, s[28:31], s38 offen offset:2048 sc1
  buffer_load_dwordx4 v[92:95], v1, s[28:31], s38 offen offset:3072 sc1
  s_add_u32 s38, s38, 4096
  buffer_load_dwordx4 v[96:99], v1, s[28:31], s38 offen offset:0 sc1
  buffer_load_dwordx4 v[100:103], v1, s[28:31], s38 offen offset:1024 sc1
  buffer_load_dwordx4 v[104:107], v1, s[28:31], s38 offen offset:2048 sc1
  buffer_load_dwordx4 v[108:111], v1, s[28:31], s38 offen offset:3072 sc1
  s_add_u32 s38, s38, 4096
  buffer_load_dwordx4 v[112:115], v1, s[28:31], s38 offen offset:0 sc1
  buffer_load_dwordx4 v[116:119], v1, s[28:31], s38 offen offset:1024 sc1
  buffer_load_dwordx4 v[120:123], v1, s[28:31], s38 offen offset:2048 sc1
  buffer_load_dwordx4 v[124:127], v1, s[28:31], s38 offen offset:3072 sc1
  s_add_u32 s38, s38, 4096
  buffer_load_dwordx4 v[128:131], v1, s[28:31], s38 offen offset:0 sc1
  buffer_load_dwordx4 v[132:135], v1, s[28:31], s38 offen offset:1024 sc1
  buffer_load_dwordx4 v[136:139], v1, s[28:31], s38 offen offset:2048 sc1
  buffer_load_dwordx4 v[140:143], v1, s[28:31], s38 offen offset:3072 sc1
  s_add_u32 s38, s38, 4096
  buffer_load_dwordx4 v[144:147], v1, s[28:31], s38 offen offset:0 sc1
  buffer_load_dwordx4 v[148:151], v1, s[28:31], s38 offen offset:1024 sc1
  buffer_load_dwordx4 v[152:155], v1, s[28:31], s38 offen offset:2048 sc1
  buffer_load_dwordx4 v[156:159], v1, s[28:31], s38 offen offset:3072 sc1
  s_add_u32 s38, s38, 4096
  buffer_load_dwordx4 v[160:163], v1, s[28:31], s38 offen offset:0 sc1
  buffer_load_dwordx4 v[164:167], v1, s[28:31], s38 offen offset:1024 sc1
  buffer_load_dwordx4 v[168:171], v1, s[28:31], s38 offen offset:2048 sc1
  buffer_load_dwordx4 v[172:175], v1, s[28:31], s38 offen offset:3072 sc1
  s_add_u32 s38, s38, 4096
  buffer_load_dwordx4 v[176:179], v1, s[28:31], s38 offen offset:0 sc1
  buffer_load_dwordx4 v[180:183], v1, s[28:31], s38 offen offset:1024 sc1
  buffer_load_dwordx4 v[184:187], v1, s[28:31], s38 offen offset:2048 sc1
  buffer_load_dwordx4 v[188:191], v1, s[28:31], s38 offen offset:3072 sc1
  ds_read_b64_tr_b16 v[192:193], v56 offset:0
  ds_read_b64_tr_b16 v[194:195], v56 offset:1024
  ds_read_b64_tr_b16 v[196:197], v57 offset:0
  ds_read_b64_tr_b16 v[198:199], v57 offset:1024
  ds_read_b64_tr_b16 v[200:201], v58 offset:0
  ds_read_b64_tr_b16 v[202:203], v58 offset:1024
  ds_read_b64_tr_b16 v[204:205], v59 offset:0
  ds_read_b64_tr_b16 v[206:207], v59 offset:1024
  ds_read_b64_tr_b16 v[208:209], v56 offset:4096
  ds_read_b64_tr_b16 v[210:211], v56 offset:5120
  ds_read_b64_tr_b16 v[212:213], v57 offset:4096
  ds_read_b64_tr_b16 v[214:215], v57 offset:5120
  ds_read_b64_tr_b16 v[216:217], v58 offset:4096
  ds_read_b64_tr_b16 v[218:219], v58 offset:5120
  ds_read_b64_tr_b16 v[220:221], v59 offset:4096
  ds_read_b64_tr_b16 v[222:223], v59 offset:5120
  s_waitcnt vmcnt(31) lgkmcnt(8)
  v_mfma_f32_16x16x32_bf16 v[8:11], v[192:195], v[64:67], v[8:11]
  ds_read_b64_tr_b16 v[224:225], v56 offset:8192
  ds_read_b64_tr_b16 v[226:227], v56 offset:9216
  v_mfma_f32_16x16x32_bf16 v[12:15], v[196:199], v[64:67], v[12:15]
  ds_read_b64_tr_b16 v[228:229], v57 offset:8192
  ds_read_b64_tr_b16 v[230:231], v57 offset:9216
  v_mfma_f32_16x16x32_bf16 v[16:19], v[200:203], v[64:67], v[16:19]
  ds_read_b64_tr_b16 v[232:233], v58 offset:8192
  ds_read_b64_tr_b16 v[234:235], v58 offset:9216
  v_mfma_f32_16x16x32_bf16 v[20:23], v[204:207], v[64:67], v[20:23]
  ds_read_b64_tr_b16 v[236:237], v59 offset:8192
  ds_read_b64_tr_b16 v[238:239], v59 offset:9216
  s_waitcnt vmcnt(30) lgkmcnt(8)
  v_mfma_f32_16x16x32_bf16 v[8:11], v[208:211], v[68:71], v[8:11]
  ds_read_b64_tr_b16 v[192:193], v56 offset:12288
  ds_read_b64_tr_b16 v[194:195], v56 offset:13312
  v_mfma_f32_16x16x32_bf16 v[12:15], v[212:215], v[68:71], v[12:15]
  ds_read_b64_tr_b16 v[196:197], v57 offset:12288
  ds_read_b64_tr_b16 v[198:199], v57 offset:13312
  v_mfma_f32_16x16x32_bf16 v[16:19], v[216:219], v[68:71], v[16:19]
  ds_read_b64_tr_b16 v[200:201], v58 offset:12288
  ds_read_b64_tr_b16 v[202:203], v58 offset:13312
  v_mfma_f32_16x16x32_bf16 v[20:23], v[220:223], v[68:71], v[20:23]
  ds_read_b64_tr_b16 v[204:205], v59 offset:12288
  ds_read_b64_tr_b16 v[206:207], v59 offset:13312
  s_waitcnt vmcnt(29) lgkmcnt(8)
  v_mfma_f32_16x16x32_bf16 v[8:11], v[224:227], v[72:75], v[8:11]
  ds_read_b64_tr_b16 v[208:209], v56 offset:16384
  ds_read_b64_tr_b16 v[210:211], v56 offset:17408
  v_mfma_f32_16x16x32_bf16 v[12:15], v[228:231], v[72:75], v[12:15]
  ds_read_b64_tr_b16 v[212:213], v57 offset:16384
  ds_read_b64_tr_b16 v[214:215], v57 offset:17408
  v_mfma_f32_16x16x32_bf16 v[16:19], v[232:235], v[72:75], v[16:19]
  ds_read_b64_tr_b16 v[216:217], v58 offset:16384
  ds_read_b64_tr_b16 v[218:219], v58 offset:17408
  v_mfma_f32_16x16x32_bf16 v[20:23], v[236:239], v[72:75], v[20:23]
  ds_read_b64_tr_b16 v[220:221], v59 offset:16384
  ds_read_b64_tr_b16 v[222:223], v59 offset:17408
  s_waitcnt vmcnt(28) lgkmcnt(8)
  v_mfma_f32_16x16x32_bf16 v[8:11], v[192:195], v[76:79], v[8:11]
  ds_read_b64_tr_b16 v[224:225], v56 offset:20480
  ds_read_b64_tr_b16 v[226:227], v56 offset:21504
  v_mfma_f32_16x16x32_bf16 v[12:15], v[196:199], v[76:79], v[12:15]
  ds_read_b64_tr_b16 v[228:229], v57 offset:20480
  ds_read_b64_tr_b16 v[230:231], v57 offset:21504
  v_mfma_f32_16x16x32_bf16 v[16:19], v[200:203], v[76:79], v[16:19]
  ds_read_b64_tr_b16 v[232:233], v58 offset:20480
  ds_read_b64_tr_b16 v[234:235], v58 offset:21504
  v_mfma_f32_16x16x32_bf16 v[20:23], v[204:207], v[76:79], v[20:23]
  ds_read_b64_tr_b16 v[236:237], v59 offset:20480
  ds_read_b64_tr_b16 v[238:239], v59 offset:21504
  s_waitcnt vmcnt(27) lgkmcnt(8)
  v_mfma_f32_16x16x32_bf16 v[8:11], v[208:211], v[80:83], v[8:11]
  ds_read_b64_tr_b16 v[192:193], v56 offset:24576
  ds_read_b64_tr_b16 v[194:195], v56 offset:25600
  v_mfma_f32_16x16x32_bf16 v[12:15], v[212:215], v[80:83], v[12:15]
  ds_read_b64_tr_b16 v[196:197], v57 offset:24576
  ds_read_b64_tr_b16 v[198:199], v57 offset:25600
  v_mfma_f32_16x16x32_bf16 v[16:19], v[216:219], v[80:83], v[16:19]
  ds_read_b64_tr_b16 v[200:201], v58 offset:24576
  ds_read_b64_tr_b16 v[202:203], v58 offset:25600
  v_mfma_f32_16x16x32_bf16 v[20:23], v[220:223], v[80:83], v[20:23]
  ds_read_b64_tr_b16 v[204:205], v59 offset:24576
  ds_read_b64_tr_b16 v[206:207], v59 offset:25600
  s_waitcnt vmcnt(26) lgkmcnt(8)
  v_mfma_f32_16x16x32_bf16 v[8:11], v[224:227], v[84:87], v[8:11]
  ds_read_b64_tr_b16 v[208:209], v56 offset:28672
  ds_read_b64_tr_b16 v[210:211], v56 offset:29696
  v_mfma_f32_16x16x32_bf16 v[12:15], v[228:231], v[84:87], v[12:15]
  ds_read_b64_tr_b16 v[212:213], v57 offset:28672
  ds_read_b64_tr_b16 v[214:215], v57 offset:29696
  v_mfma_f32_16x16x32_bf16 v[16:19], v[232:235], v[84:87], v[16:19]
  ds_read_b64_tr_b16 v[216:217], v58 offset:28672
  ds_read_b64_tr_b16 v[218:219], v58 offset:29696
  v_mfma_f32_16x16x32_bf16 v[20:23], v[236:239], v[84:87], v[20:23]
  ds_read_b64_tr_b16 v[220:221], v59 offset:28672
  ds_read_b64_tr_b16 v[222:223], v59 offset:29696
  s_waitcnt vmcnt(25) lgkmcnt(8)
  v_mfma_f32_16x16x32_bf16 v[8:11], v[192:195], v[88:91], v[8:11]
  ds_read_b64_tr_b16 v[224:225], v56 offset:32768
  ds_read_b64_tr_b16 v[226:227], v56 offset:33792
  v_mfma_f32_16x16x32_bf16 v[12:15], v[196:199], v[88:91], v[12:15]
  ds_read_b64_tr_b16 v[228:229], v57 offset:32768
  ds_read_b64_tr_b16 v[230:231], v57 offset:33792
  v_mfma_f32_16x16x32_bf16 v[16:19], v[200:203], v[88:91], v[16:19]
  ds_read_b64_tr_b16 v[232:233], v58 offset:32768
  ds_read_b64_tr_b16 v[234:235], v58 offset:33792
  v_mfma_f32_16x16x32_bf16 v[20:23], v[204:207], v[88:91], v[20:23]
  ds_read_b64_tr_b16 v[236:237], v59 offset:32768
  ds_read_b64_tr_b16 v[238:239], v59 offset:33792
  s_waitcnt vmcnt(24) lgkmcnt(8)
  v_mfma_f32_16x16x32_bf16 v[8:11], v[208:211], v[92:95], v[8:11]
  ds_read_b64_tr_b16 v[192:193], v56 offset:36864
  ds_read_b64_tr_b16 v[194:195], v56 offset:37888
  v_mfma_f32_16x16x32_bf16 v[12:15], v[212:215], v[92:95], v[12:15]
  ds_read_b64_tr_b16 v[196:197], v57 offset:36864
  ds_read_b64_tr_b16 v[198:199], v57 offset:37888
  v_mfma_f32_16x16x32_bf16 v[16:19], v[216:219], v[92:95], v[16:19]
  ds_read_b64_tr_b16 v[200:201], v58 offset:36864
  ds_read_b64_tr_b16 v[202:203], v58 offset:37888
  v_mfma_f32_16x16x32_bf16 v[20:23], v[220:223], v[92:95], v[20:23]
  ds_read_b64_tr_b16 v[204:205], v59 offset:36864
  ds_read_b64_tr_b16 v[206:207], v59 offset:37888
  s_waitcnt vmcnt(23) lgkmcnt(8)
  v_mfma_f32_16x16x32_bf16 v[8:11], v[224:227], v[96:99], v[8:11]
  ds_read_b64_tr_b16 v[208:209], v56 offset:40960
  ds_read_b64_tr_b16 v[210:211], v56 offset:41984
  v_mfma_f32_16x16x32_bf16 v[12:15], v[228:231], v[96:99], v[12:15]
  ds_read_b64_tr_b16 v[212:213], v57 offset:40960
  ds_read_b64_tr_b16 v[214:215], v57 offset:41984
  v_mfma_f32_16x16x32_bf16 v[16:19], v[232:235], v[96:99], v[16:19]
  ds_read_b64_tr_b16 v[216:217], v58 offset:40960
  ds_read_b64_tr_b16 v[218:219], v58 offset:41984
  v_mfma_f32_16x16x32_bf16 v[20:23], v[236:239], v[96:99], v[20:23]
  ds_read_b64_tr_b16 v[220:221], v59 offset:40960
  ds_read_b64_tr_b16 v[222:223], v59 offset:41984
  s_waitcnt vmcnt(22) lgkmcnt(8)
  v_mfma_f32_16x16x32_bf16 v[8:11], v[192:195], v[100:103], v[8:11]
  ds_read_b64_tr_b16 v[224:225], v56 offset:45056
  ds_read_b64_tr_b16 v[226:227], v56 offset:46080
  v_mfma_f32_16x16x32_bf16 v[12:15], v[196:199], v[100:103], v[12:15]
  ds_read_b64_tr_b16 v[228:229], v57 offset:45056
  ds_read_b64_tr_b16 v[230:231], v57 offset:46080
  v_mfma_f32_16x16x32_bf16 v[16:19], v[200:203], v[100:103], v[16:19]
  ds_read_b64_tr_b16 v[232:233], v58 offset:45056
  ds_read_b64_tr_b16 v[234:235], v58 offset:46080
  v_mfma_f32_16x16x32_bf16 v[20:23], v[204:207], v[100:103], v[20:23]
  ds_read_b64_tr_b16 v[236:237], v59 offset:45056
  ds_read_b64_tr_b16 v[238:239], v59 offset:46080
  s_waitcnt vmcnt(21) lgkmcnt(8)
  v_mfma_f32_16x16x32_bf16 v[8:11], v[208:211], v[104:107], v[8:11]
  ds_read_b64_tr_b16 v[192:193], v56 offset:49152
  ds_read_b64_tr_b16 v[194:195], v56 offset:50176
  v_mfma_f32_16x16x32_bf16 v[12:15], v[212:215], v[104:107], v[12:15]
  ds_read_b64_tr_b16 v[196:197], v57 offset:49152
  ds_read_b64_tr_b16 v[198:199], v57 offset:50176
  v_mfma_f32_16x16x32_bf16 v[16:19], v[216:219], v[104:107], v[16:19]
  ds_read_b64_tr_b16 v[200:201], v58 offset:49152
  ds_read_b64_tr_b16 v[202:203], v58 offset:50176
  v_mfma_f32_16x16x32_bf16 v[20:23], v[220:223], v[104:107], v[20:23]
  ds_read_b64_tr_b16 v[204:205], v59 offset:49152
  ds_read_b64_tr_b16 v[206:207], v59 offset:50176
  s_waitcnt vmcnt(20) lgkmcnt(8)
  v_mfma_f32_16x16x32_bf16 v[8:11], v[224:227], v[108:111], v[8:11]
  ds_read_b64_tr_b16 v[208:209], v56 offset:53248
  ds_read_b64_tr_b16 v[210:211], v56 offset:54272
  v_mfma_f32_16x16x32_bf16 v[12:15], v[228:231], v[108:111], v[12:15]
  ds_read_b64_tr_b16 v[212:213], v57 offset:53248
  ds_read_b64_tr_b16 v[214:215], v57 offset:54272
  v_mfma_f32_16x16x32_bf16 v[16:19], v[232:235], v[108:111], v[16:19]
  ds_read_b64_tr_b16 v[216:217], v58 offset:53248
  ds_read_b64_tr_b16 v[218:219], v58 offset:54272
  v_mfma_f32_16x16x32_bf16 v[20:23], v[236:239], v[108:111], v[20:23]
  ds_read_b64_tr_b16 v[220:221], v59 offset:53248
  ds_read_b64_tr_b16 v[222:223], v59 offset:54272
  s_waitcnt vmcnt(19) lgkmcnt(8)
  v_mfma_f32_16x16x32_bf16 v[8:11], v[192:195], v[112:115], v[8:11]
  ds_read_b64_tr_b16 v[224:225], v56 offset:57344
  ds_read_b64_tr_b16 v[226:227], v56 offset:58368
  v_mfma_f32_16x16x32_bf16 v[12:15], v[196:199], v[112:115], v[12:15]
  ds_read_b64_tr_b16 v[228:229], v57 offset:57344
  ds_read_b64_tr_b16 v[230:231], v57 offset:58368
  v_mfma_f32_16x16x32_bf16 v[16:19], v[200:203], v[112:115], v[16:19]
  ds_read_b64_tr_b16 v[232:233], v58 offset:57344
  ds_read_b64_tr_b16 v[234:235], v58 offset:58368
  v_mfma_f32_16x16x32_bf16 v[20:23], v[204:207], v[112:115], v[20:23]
  ds_read_b64_tr_b16 v[236:237], v59 offset:57344
  ds_read_b64_tr_b16 v[238:239], v59 offset:58368
  s_waitcnt vmcnt(18) lgkmcnt(8)
  v_mfma_f32_16x16x32_bf16 v[8:11], v[208:211], v[116:119], v[8:11]
  ds_read_b64_tr_b16 v[192:193], v56 offset:61440
  ds_read_b64_tr_b16 v[194:195], v56 offset:62464
  v_mfma_f32_16x16x32_bf16 v[12:15], v[212:215], v[116:119], v[12:15]
  ds_read_b64_tr_b16 v[196:197], v57 offset:61440
  ds_read_b64_tr_b16 v[198:199], v57 offset:62464
  v_mfma_f32_16x16x32_bf16 v[16:19], v[216:219], v[116:119], v[16:19]
  ds_read_b64_tr_b16 v[200:201], v58 offset:61440
  ds_read_b64_tr_b16 v[202:203], v58 offset:62464
  v_mfma_f32_16x16x32_bf16 v[20:23], v[220:223], v[116:119], v[20:23]
  ds_read_b64_tr_b16 v[204:205], v59 offset:61440
  ds_read_b64_tr_b16 v[206:207], v59 offset:62464
  s_waitcnt vmcnt(17) lgkmcnt(8)
  v_mfma_f32_16x16x32_bf16 v[8:11], v[224:227], v[120:123], v[8:11]
  ds_read_b64_tr_b16 v[208:209], v60 offset:0
  ds_read_b64_tr_b16 v[210:211], v60 offset:1024
  v_mfma_f32_16x16x32_bf16 v[12:15], v[228:231], v[120:123], v[12:15]
  ds_read_b64_tr_b16 v[212:213], v61 offset:0
  ds_read_b64_tr_b16 v[214:215], v61 offset:1024
  v_mfma_f32_16x16x32_bf16 v[16:19], v[232:235], v[120:123], v[16:19]
  ds_read_b64_tr_b16 v[216:217], v62 offset:0
  ds_read_b64_tr_b16 v[218:219], v62 offset:1024
  v_mfma_f32_16x16x32_bf16 v[20:23], v[236:239], v[120:123], v[20:23]
  ds_read_b64_tr_b16 v[220:221], v63 offset:0
  ds_read_b64_tr_b16 v[222:223], v63 offset:1024
  s_waitcnt vmcnt(16) lgkmcnt(8)
  v_mfma_f32_16x16x32_bf16 v[8:11], v[192:195], v[124:127], v[8:11]
  ds_read_b64_tr_b16 v[224:225], v60 offset:4096
  ds_read_b64_tr_b16 v[226:227], v60 offset:5120
  v_mfma_f32_16x16x32_bf16 v[12:15], v[196:199], v[124:127], v[12:15]
  ds_read_b64_tr_b16 v[228:229], v61 offset:4096
  ds_read_b64_tr_b16 v[230:231], v61 offset:5120
  v_mfma_f32_16x16x32_bf16 v[16:19], v[200:203], v[124:127], v[16:19]
  ds_read_b64_tr_b16 v[232:233], v62 offset:4096
  ds_read_b64_tr_b16 v[234:235], v62 offset:5120
  v_mfma_f32_16x16x32_bf16 v[20:23], v[204:207], v[124:127], v[20:23]
  ds_read_b64_tr_b16 v[236:237], v63 offset:4096
  ds_read_b64_tr_b16 v[238:239], v63 offset:5120
  s_waitcnt vmcnt(15) lgkmcnt(8)
  v_mfma_f32_16x16x32_bf16 v[8:11], v[208:211], v[128:131], v[8:11]
  ds_read_b64_tr_b16 v[192:193], v60 offset:8192
  ds_read_b64_tr_b16 v[194:195], v60 offset:9216
  v_mfma_f32_16x16x32_bf16 v[12:15], v[212:215], v[128:131], v[12:15]
  ds_read_b64_tr_b16 v[196:197], v61 offset:8192
  ds_read_b64_tr_b16 v[198:199], v61 offset:9216
  v_mfma_f32_16x16x32_bf16 v[16:19], v[216:219], v[128:131], v[16:19]
  ds_read_b64_tr_b16 v[200:201], v62 offset:8192
  ds_read_b64_tr_b16 v[202:203], v62 offset:9216
  v_mfma_f32_16x16x32_bf16 v[20:23], v[220:223], v[128:131], v[20:23]
  ds_read_b64_tr_b16 v[204:205], v63 offset:8192
  ds_read_b64_tr_b16 v[206:207], v63 offset:9216
  s_waitcnt vmcnt(14) lgkmcnt(8)
  v_mfma_f32_16x16x32_bf16 v[8:11], v[224:227], v[132:135], v[8:11]
  ds_read_b64_tr_b16 v[208:209], v60 offset:12288
  ds_read_b64_tr_b16 v[210:211], v60 offset:13312
  v_mfma_f32_16x16x32_bf16 v[12:15], v[228:231], v[132:135], v[12:15]
  ds_read_b64_tr_b16 v[212:213], v61 offset:12288
  ds_read_b64_tr_b16 v[214:215], v61 offset:13312
  v_mfma_f32_16x16x32_bf16 v[16:19], v[232:235], v[132:135], v[16:19]
  ds_read_b64_tr_b16 v[216:217], v62 offset:12288
  ds_read_b64_tr_b16 v[218:219], v62 offset:13312
  v_mfma_f32_16x16x32_bf16 v[20:23], v[236:239], v[132:135], v[20:23]
  ds_read_b64_tr_b16 v[220:221], v63 offset:12288
  ds_read_b64_tr_b16 v[222:223], v63 offset:13312
  s_waitcnt vmcnt(13) lgkmcnt(8)
  v_mfma_f32_16x16x32_bf16 v[8:11], v[192:195], v[136:139], v[8:11]
  ds_read_b64_tr_b16 v[224:225], v60 offset:16384
  ds_read_b64_tr_b16 v[226:227], v60 offset:17408
  v_mfma_f32_16x16x32_bf16 v[12:15], v[196:199], v[136:139], v[12:15]
  ds_read_b64_tr_b16 v[228:229], v61 offset:16384
  ds_read_b64_tr_b16 v[230:231], v61 offset:17408
  v_mfma_f32_16x16x32_bf16 v[16:19], v[200:203], v[136:139], v[16:19]
  ds_read_b64_tr_b16 v[232:233], v62 offset:16384
  ds_read_b64_tr_b16 v[234:235], v62 offset:17408
  v_mfma_f32_16x16x32_bf16 v[20:23], v[204:207], v[136:139], v[20:23]
  ds_read_b64_tr_b16 v[236:237], v63 offset:16384
  ds_read_b64_tr_b16 v[238:239], v63 offset:17408
  s_waitcnt vmcnt(12) lgkmcnt(8)
  v_mfma_f32_16x16x32_bf16 v[8:11], v[208:211], v[140:143], v[8:11]
  ds_read_b64_tr_b16 v[192:193], v60 offset:20480
  ds_read_b64_tr_b16 v[194:195], v60 offset:21504
  v_mfma_f32_16x16x32_bf16 v[12:15], v[212:215], v[140:143], v[12:15]
  ds_read_b64_tr_b16 v[196:197], v61 offset:20480
  ds_read_b64_tr_b16 v[198:199], v61 offset:21504
  v_mfma_f32_16x16x32_bf16 v[16:19], v[216:219], v[140:143], v[16:19]
  ds_read_b64_tr_b16 v[200:201], v62 offset:20480
  ds_read_b64_tr_b16 v[202:203], v62 offset:21504
  v_mfma_f32_16x16x32_bf16 v[20:23], v[220:223], v[140:143], v[20:23]
  ds_read_b64_tr_b16 v[204:205], v63 offset:20480
  ds_read_b64_tr_b16 v[206:207], v63 offset:21504
  s_waitcnt vmcnt(11) lgkmcnt(8)
  v_mfma_f32_16x16x32_bf16 v[8:11], v[224:227], v[144:147], v[8:11]
  ds_read_b64_tr_b16 v[208:209], v60 offset:24576
  ds_read_b64_tr_b16 v[210:211], v60 offset:25600
  v_mfma_f32_16x16x32_bf16 v[12:15], v[228:231], v[144:147], v[12:15]
  ds_read_b64_tr_b16 v[212:213], v61 offset:24576
  ds_read_b64_tr_b16 v[214:215], v61 offset:25600
  v_mfma_f32_16x16x32_bf16 v[16:19], v[232:235], v[144:147], v[16:19]
  ds_read_b64_tr_b16 v[216:217], v62 offset:24576
  ds_read_b64_tr_b16 v[218:219], v62 offset:25600
  v_mfma_f32_16x16x32_bf16 v[20:23], v[236:239], v[144:147], v[20:23]
  ds_read_b64_tr_b16 v[220:221], v63 offset:24576
  ds_read_b64_tr_b16 v[222:223], v63 offset:25600
  s_waitcnt vmcnt(10) lgkmcnt(8)
  v_mfma_f32_16x16x32_bf16 v[8:11], v[192:195], v[148:151], v[8:11]
  ds_read_b64_tr_b16 v[224:225], v60 offset:28672
  ds_read_b64_tr_b16 v[226:227], v60 offset:29696
  v_mfma_f32_16x16x32_bf16 v[12:15], v[196:199], v[148:151], v[12:15]
  ds_read_b64_tr_b16 v[228:229], v61 offset:28672
  ds_read_b64_tr_b16 v[230:231], v61 offset:29696
  v_mfma_f32_16x16x32_bf16 v[16:19], v[200:203], v[148:151], v[16:19]
  ds_read_b64_tr_b16 v[232:233], v62 offset:28672
  ds_read_b64_tr_b16 v[234:235], v62 offset:29696
  v_mfma_f32_16x16x32_bf16 v[20:23], v[204:207], v[148:151], v[20:23]
  ds_read_b64_tr_b16 v[236:237], v63 offset:28672
  ds_read_b64_tr_b16 v[238:239], v63 offset:29696
  s_waitcnt vmcnt(9) lgkmcnt(8)
  v_mfma_f32_16x16x32_bf16 v[8:11], v[208:211], v[152:155], v[8:11]
  ds_read_b64_tr_b16 v[192:193], v60 offset:32768
  ds_read_b64_tr_b16 v[194:195], v60 offset:33792
  v_mfma_f32_16x16x32_bf16 v[12:15], v[212:215], v[152:155], v[12:15]
  ds_read_b64_tr_b16 v[196:197], v61 offset:32768
  ds_read_b64_tr_b16 v[198:199], v61 offset:33792
  v_mfma_f32_16x16x32_bf16 v[16:19], v[216:219], v[152:155], v[16:19]
  ds_read_b64_tr_b16 v[200:201], v62 offset:32768
  ds_read_b64_tr_b16 v[202:203], v62 offset:33792
  v_mfma_f32_16x16x32_bf16 v[20:23], v[220:223], v[152:155], v[20:23]
  ds_read_b64_tr_b16 v[204:205], v63 offset:32768
  ds_read_b64_tr_b16 v[206:207], v63 offset:33792
  s_waitcnt vmcnt(8) lgkmcnt(8)
  v_mfma_f32_16x16x32_bf16 v[8:11], v[224:227], v[156:159], v[8:11]
  ds_read_b64_tr_b16 v[208:209], v60 offset:36864
  ds_read_b64_tr_b16 v[210:211], v60 offset:37888
  v_mfma_f32_16x16x32_bf16 v[12:15], v[228:231], v[156:159], v[12:15]
  ds_read_b64_tr_b16 v[212:213], v61 offset:36864
  ds_read_b64_tr_b16 v[214:215], v61 offset:37888
  v_mfma_f32_16x16x32_bf16 v[16:19], v[232:235], v[156:159], v[16:19]
  ds_read_b64_tr_b16 v[216:217], v62 offset:36864
  ds_read_b64_tr_b16 v[218:219], v62 offset:37888
  v_mfma_f32_16x16x32_bf16 v[20:23], v[236:239], v[156:159], v[20:23]
  ds_read_b64_tr_b16 v[220:221], v63 offset:36864
  ds_read_b64_tr_b16 v[222:223], v63 offset:37888
  s_waitcnt vmcnt(7) lgkmcnt(8)
  v_mfma_f32_16x16x32_bf16 v[8:11], v[192:195], v[160:163], v[8:11]
  ds_read_b64_tr_b16 v[224:225], v60 offset:40960
  ds_read_b64_tr_b16 v[226:227], v60 offset:41984
  v_mfma_f32_16x16x32_bf16 v[12:15], v[196:199], v[160:163], v[12:15]
  ds_read_b64_tr_b16 v[228:229], v61 offset:40960
  ds_read_b64_tr_b16 v[230:231], v61 offset:41984
  v_mfma_f32_16x16x32_bf16 v[16:19], v[200:203], v[160:163], v[16:19]
  ds_read_b64_tr_b16 v[232:233], v62 offset:40960
  ds_read_b64_tr_b16 v[234:235], v62 offset:41984
  v_mfma_f32_16x16x32_bf16 v[20:23], v[204:207], v[160:163], v[20:23]
  ds_read_b64_tr_b16 v[236:237], v63 offset:40960
  ds_read_b64_tr_b16 v[238:239], v63 offset:41984
  s_waitcnt vmcnt(6) lgkmcnt(8)
  v_mfma_f32_16x16x32_bf16 v[8:11], v[208:211], v[164:167], v[8:11]
  ds_read_b64_tr_b16 v[192:193], v60 offset:45056
  ds_read_b64_tr_b16 v[194:195], v60 offset:46080
  v_mfma_f32_16x16x32_bf16 v[12:15], v[212:215], v[164:167], v[12:15]
  ds_read_b64_tr_b16 v[196:197], v61 offset:45056
  ds_read_b64_tr_b16 v[198:199], v61 offset:46080
  v_mfma_f32_16x16x32_bf16 v[16:19], v[216:219], v[164:167], v[16:19]
  ds_read_b64_tr_b16 v[200:201], v62 offset:45056
  ds_read_b64_tr_b16 v[202:203], v62 offset:46080
  v_mfma_f32_16x16x32_bf16 v[20:23], v[220:223], v[164:167], v[20:23]
  ds_read_b64_tr_b16 v[204:205], v63 offset:45056
  ds_read_b64_tr_b16 v[206:207], v63 offset:46080
  s_waitcnt vmcnt(5) lgkmcnt(8)
  v_mfma_f32_16x16x32_bf16 v[8:11], v[224:227], v[168:171], v[8:11]
  ds_read_b64_tr_b16 v[208:209], v60 offset:49152
  ds_read_b64_tr_b16 v[210:211], v60 offset:50176
  v_mfma_f32_16x16x32_bf16 v[12:15], v[228:231], v[168:171], v[12:15]
  ds_read_b64_tr_b16 v[212:213], v61 offset:49152
  ds_read_b64_tr_b16 v[214:215], v61 offset:50176
  v_mfma_f32_16x16x32_bf16 v[16:19], v[232:235], v[168:171], v[16:19]
  ds_read_b64_tr_b16 v[216:217], v62 offset:49152
  ds_read_b64_tr_b16 v[218:219], v62 offset:50176
  v_mfma_f32_16x16x32_bf16 v[20:23], v[236:239], v[168:171], v[20:23]
  ds_read_b64_tr_b16 v[220:221], v63 offset:49152
  ds_read_b64_tr_b16 v[222:223], v63 offset:50176
  s_waitcnt vmcnt(4) lgkmcnt(8)
  v_mfma_f32_16x16x32_bf16 v[8:11], v[192:195], v[172:175], v[8:11]
  ds_read_b64_tr_b16 v[224:225], v60 offset:53248
  ds_read_b64_tr_b16 v[226:227], v60 offset:54272
  v_mfma_f32_16x16x32_bf16 v[12:15], v[196:199], v[172:175], v[12:15]
  ds_read_b64_tr_b16 v[228:229], v61 offset:53248
  ds_read_b64_tr_b16 v[230:231], v61 offset:54272
  v_mfma_f32_16x16x32_bf16 v[16:19], v[200:203], v[172:175], v[16:19]
  ds_read_b64_tr_b16 v[232:233], v62 offset:53248
  ds_read_b64_tr_b16 v[234:235], v62 offset:54272
  v_mfma_f32_16x16x32_bf16 v[20:23], v[204:207], v[172:175], v[20:23]
  ds_read_b64_tr_b16 v[236:237], v63 offset:53248
  ds_read_b64_tr_b16 v[238:239], v63 offset:54272
  s_waitcnt vmcnt(3) lgkmcnt(8)
  v_mfma_f32_16x16x32_bf16 v[8:11], v[208:211], v[176:179], v[8:11]
  ds_read_b64_tr_b16 v[192:193], v60 offset:57344
  ds_read_b64_tr_b16 v[194:195], v60 offset:58368
  v_mfma_f32_16x16x32_bf16 v[12:15], v[212:215], v[176:179], v[12:15]
  ds_read_b64_tr_b16 v[196:197], v61 offset:57344
  ds_read_b64_tr_b16 v[198:199], v61 offset:58368
  v_mfma_f32_16x16x32_bf16 v[16:19], v[216:219], v[176:179], v[16:19]
  ds_read_b64_tr_b16 v[200:201], v62 offset:57344
  ds_read_b64_tr_b16 v[202:203], v62 offset:58368
  v_mfma_f32_16x16x32_bf16 v[20:23], v[220:223], v[176:179], v[20:23]
  ds_read_b64_tr_b16 v[204:205], v63 offset:57344
  ds_read_b64_tr_b16 v[206:207], v63 offset:58368
  s_waitcnt vmcnt(2) lgkmcnt(8)
  v_mfma_f32_16x16x32_bf16 v[8:11], v[224:227], v[180:183], v[8:11]
  ds_read_b64_tr_b16 v[208:209], v60 offset:61440
  ds_read_b64_tr_b16 v[210:211], v60 offset:62464
  v_mfma_f32_16x16x32_bf16 v[12:15], v[228:231], v[180:183], v[12:15]
  ds_read_b64_tr_b16 v[212:213], v61 offset:61440
  ds_read_b64_tr_b16 v[214:215], v61 offset:62464
  v_mfma_f32_16x16x32_bf16 v[16:19], v[232:235], v[180:183], v[16:19]
  ds_read_b64_tr_b16 v[216:217], v62 offset:61440
  ds_read_b64_tr_b16 v[218:219], v62 offset:62464
  v_mfma_f32_16x16x32_bf16 v[20:23], v[236:239], v[180:183], v[20:23]
  ds_read_b64_tr_b16 v[220:221], v63 offset:61440
  ds_read_b64_tr_b16 v[222:223], v63 offset:62464
  s_waitcnt vmcnt(1) lgkmcnt(8)
  v_mfma_f32_16x16x32_bf16 v[8:11], v[192:195], v[184:187], v[8:11]
  v_mfma_f32_16x16x32_bf16 v[12:15], v[196:199], v[184:187], v[12:15]
  v_mfma_f32_16x16x32_bf16 v[16:19], v[200:203], v[184:187], v[16:19]
  v_mfma_f32_16x16x32_bf16 v[20:23], v[204:207], v[184:187], v[20:23]
  s_waitcnt vmcnt(0) lgkmcnt(0)
  v_mfma_f32_16x16x32_bf16 v[8:11], v[208:211], v[188:191], v[8:11]
  v_mfma_f32_16x16x32_bf16 v[12:15], v[212:215], v[188:191], v[12:15]
  v_mfma_f32_16x16x32_bf16 v[16:19], v[216:219], v[188:191], v[16:19]
  v_mfma_f32_16x16x32_bf16 v[20:23], v[220:223], v[188:191], v[20:23]
  s_nop 7
  v_cvt_pk_bf16_f32 v32, v8, v9
  v_cvt_pk_bf16_f32 v33, v10, v11
  v_cvt_pk_bf16_f32 v34, v12, v13
  v_cvt_pk_bf16_f32 v35, v14, v15
  v_cvt_pk_bf16_f32 v36, v16, v17
  v_cvt_pk_bf16_f32 v37, v18, v19
  v_cvt_pk_bf16_f32 v38, v20, v21
  v_cvt_pk_bf16_f32 v39, v22, v23
  s_nop 1
  v_permlane16_swap_b32 v32, v34
  v_permlane16_swap_b32 v36, v38
  v_permlane16_swap_b32 v33, v35
  v_permlane16_swap_b32 v37, v39
  s_nop 1
  v_permlane32_swap_b32 v32, v36
  v_permlane32_swap_b32 v34, v38
  v_permlane32_swap_b32 v33, v37
  v_permlane32_swap_b32 v35, v39
  s_mov_b32 s24, s46
  s_and_b32 s25, s47, 0xffff
  s_mov_b32 s26, 4194304
  s_mov_b32 s27, 0x00020000
  s_lshl_b32 s36, s50, 3
  s_add_u32 s36, s36, s18
  s_lshl_b32 s36, s36, 15
  s_lshl_b32 s37, s51, 7
  s_add_u32 s36, s36, s37
  v_and_b32 v2, 15, v0
  v_lshlrev_b32 v2, 11, v2
  v_lshrrev_b32 v3, 4, v0
  v_lshl_add_u32 v2, v3, 5, v2
  buffer_store_dwordx4 v[32:35], v2, s[24:27], s36 offen nt
  buffer_store_dwordx4 v[36:39], v2, s[24:27], s36 offen offset:16 nt
  s_endpgm
standalone__softmax_full_mha__prompt_kernel_slow:
  s_waitcnt lgkmcnt(0)
  s_barrier
  s_lshl_b32 s52, s18, 14
  s_lshl_b32 s53, s18, 10
  s_add_u32 s52, s52, 2097152
  s_add_u32 s53, s53, 131072
  v_mov_b32 v104, 0
  v_mov_b32 v105, 0
  v_mov_b32 v106, 0
  v_mov_b32 v107, 0
  v_mov_b32 v108, 0
  v_mov_b32 v109, 0
  v_mov_b32 v110, 0
  v_mov_b32 v111, 0
  v_mov_b32 v112, 0
  v_mov_b32 v113, 0
  v_mov_b32 v114, 0
  v_mov_b32 v115, 0
  v_mov_b32 v116, 0
  v_mov_b32 v117, 0
  v_mov_b32 v118, 0
  v_mov_b32 v119, 0
  v_mov_b32 v120, 0
  v_mov_b32 v121, 0
  v_mov_b32 v122, 0
  v_mov_b32 v123, 0
  v_mov_b32 v124, 0
  v_mov_b32 v125, 0
  v_mov_b32 v126, 0
  v_mov_b32 v127, 0
  v_mov_b32 v128, 0
  v_mov_b32 v129, 0
  v_mov_b32 v130, 0
  v_mov_b32 v131, 0
  v_mov_b32 v132, 0
  v_mov_b32 v133, 0
  v_mov_b32 v134, 0
  v_mov_b32 v135, 0
  v_mov_b32 v136, 0
  v_mov_b32 v137, 0
  v_mov_b32 v138, 0
  v_mov_b32 v139, 0
  v_mov_b32 v140, 0
  v_mov_b32 v141, 0
  v_mov_b32 v142, 0
  v_mov_b32 v143, 0
  v_mov_b32 v144, 0
  v_mov_b32 v145, 0
  v_mov_b32 v146, 0
  v_mov_b32 v147, 0
  v_mov_b32 v148, 0
  v_mov_b32 v149, 0
  v_mov_b32 v150, 0
  v_mov_b32 v151, 0
  v_mov_b32 v152, 0
  v_mov_b32 v153, 0
  v_mov_b32 v154, 0
  v_mov_b32 v155, 0
  v_mov_b32 v156, 0
  v_mov_b32 v157, 0
  v_mov_b32 v158, 0
  v_mov_b32 v159, 0
  v_mov_b32 v160, 0
  v_mov_b32 v161, 0
  v_mov_b32 v162, 0
  v_mov_b32 v163, 0
  v_mov_b32 v164, 0
  v_mov_b32 v165, 0
  v_mov_b32 v166, 0
  v_mov_b32 v167, 0
  v_mov_b32 v168, 0
  v_mov_b32 v169, 0
  v_mov_b32 v170, 0
  v_mov_b32 v171, 0
  v_mov_b32 v172, 0
  v_mov_b32 v173, 0
  v_mov_b32 v174, 0
  v_mov_b32 v175, 0
  v_mov_b32 v176, 0
  v_mov_b32 v177, 0
  v_mov_b32 v178, 0
  v_mov_b32 v179, 0
  v_mov_b32 v180, 0
  v_mov_b32 v181, 0
  v_mov_b32 v182, 0
  v_mov_b32 v183, 0
  v_mov_b32 v184, 0
  v_mov_b32 v185, 0
  v_mov_b32 v186, 0
  v_mov_b32 v187, 0
  v_mov_b32 v188, 0
  v_mov_b32 v189, 0
  v_mov_b32 v190, 0
  v_mov_b32 v191, 0
  v_mov_b32 v192, 0
  v_mov_b32 v193, 0
  v_mov_b32 v194, 0
  v_mov_b32 v195, 0
  v_mov_b32 v196, 0
  v_mov_b32 v197, 0
  v_mov_b32 v198, 0
  v_mov_b32 v199, 0
  v_mov_b32 v56, 0
  v_mov_b32 v57, 0
  v_mov_b32 v58, 0
  v_mov_b32 v59, 0
  v_mov_b32 v60, 0
  v_mov_b32 v61, 0
  v_mov_b32 v62, 0
  v_mov_b32 v63, 0
  v_mov_b32 v64, 0
  v_mov_b32 v65, 0
  v_mov_b32 v66, 0
  v_mov_b32 v67, 0
  v_mov_b32 v68, 0
  v_mov_b32 v69, 0
  v_mov_b32 v70, 0
  v_mov_b32 v71, 0
  s_mov_b64 s[54:55], 0
  s_mov_b32 s39, 16
  v_mov_b32 v206, 0xff800000
  v_mov_b32 v207, 0xff800000
  v_mov_b32 v208, 0xff800000
  v_mov_b32 v209, 0xff800000
  s_mov_b32 s35, 0
standalone__softmax_full_mha__prompt_kernel_pre:
  s_cmp_eq_u32 s39, 0
  s_cbranch_scc1 standalone__softmax_full_mha__prompt_kernel_rdy6_oob
  s_andn2_b64 s[56:57], s[62:63], s[54:55]
  s_cbranch_scc1 standalone__softmax_full_mha__prompt_kernel_rdy6_ok
  s_mov_b32 s37, 0
standalone__softmax_full_mha__prompt_kernel_rdy6_p:
  buffer_load_dword v217, v216, s[28:31], s60 offen sc1
  s_waitcnt vmcnt(0)
  v_cmp_eq_u32 vcc, s48, v217
  s_add_u32 s37, s37, 1
  s_lshr_b64 s[62:63], vcc, s61
  s_and_b32 s62, s62, 0x11111111
  s_and_b32 s63, s63, 0x11111111
  s_cmp_gt_u32 s37, 200000
  s_cselect_b32 s36, 0x11111111, 0
  s_or_b32 s62, s62, s36
  s_or_b32 s63, s63, s36
  s_andn2_b64 s[56:57], s[62:63], s[54:55]
  s_cbranch_scc1 standalone__softmax_full_mha__prompt_kernel_rdy6_ok
  s_sleep 1
  s_branch standalone__softmax_full_mha__prompt_kernel_rdy6_p
standalone__softmax_full_mha__prompt_kernel_rdy6_ok:
  s_ff1_i32_b64 s36, s[56:57]
  s_bitset1_b64 s[54:55], s36
  s_lshl_b32 s38, s36, 12
  s_add_u32 s38, s38, s41
  s_sub_u32 s39, s39, 1
  s_branch standalone__softmax_full_mha__prompt_kernel_rdy6_e
standalone__softmax_full_mha__prompt_kernel_rdy6_oob:
  s_mov_b32 s38, 0x80000000
standalone__softmax_full_mha__prompt_kernel_rdy6_e:
  buffer_load_dwordx4 v[40:43], v1, s[28:31], s38 offen offset:0 sc1
  buffer_load_dwordx4 v[44:47], v1, s[28:31], s38 offen offset:1024 sc1
  s_waitcnt vmcnt(0)
  v_mfma_f32_32x32x16_bf16 v[72:87], v[40:43], v[8:11], 0
  v_mfma_f32_32x32x16_bf16 v[72:87], v[44:47], v[12:15], v[72:87]
  s_nop 15
  s_nop 3
  v_max3_f32 v206, v72, v73, v206
  v_max3_f32 v206, v74, v75, v206
  v_max3_f32 v206, v76, v77, v206
  v_max3_f32 v206, v78, v79, v206
  v_max3_f32 v206, v80, v81, v206
  v_max3_f32 v206, v82, v83, v206
  v_max3_f32 v206, v84, v85, v206
  v_max3_f32 v206, v86, v87, v206
  v_mfma_f32_32x32x16_bf16 v[88:103], v[40:43], v[16:19], 0
  v_mfma_f32_32x32x16_bf16 v[88:103], v[44:47], v[20:23], v[88:103]
  s_nop 15
  s_nop 3
  v_max3_f32 v207, v88, v89, v207
  v_max3_f32 v207, v90, v91, v207
  v_max3_f32 v207, v92, v93, v207
  v_max3_f32 v207, v94, v95, v207
  v_max3_f32 v207, v96, v97, v207
  v_max3_f32 v207, v98, v99, v207
  v_max3_f32 v207, v100, v101, v207
  v_max3_f32 v207, v102, v103, v207
  v_mfma_f32_32x32x16_bf16 v[72:87], v[40:43], v[24:27], 0
  v_mfma_f32_32x32x16_bf16 v[72:87], v[44:47], v[28:31], v[72:87]
  s_nop 15
  s_nop 3
  v_max3_f32 v208, v72, v73, v208
  v_max3_f32 v208, v74, v75, v208
  v_max3_f32 v208, v76, v77, v208
  v_max3_f32 v208, v78, v79, v208
  v_max3_f32 v208, v80, v81, v208
  v_max3_f32 v208, v82, v83, v208
  v_max3_f32 v208, v84, v85, v208
  v_max3_f32 v208, v86, v87, v208
  v_mfma_f32_32x32x16_bf16 v[88:103], v[40:43], v[32:35], 0
  v_mfma_f32_32x32x16_bf16 v[88:103], v[44:47], v[36:39], v[88:103]
  s_nop 15
  s_nop 3
  v_max3_f32 v209, v88, v89, v209
  v_max3_f32 v209, v90, v91, v209
  v_max3_f32 v209, v92, v93, v209
  v_max3_f32 v209, v94, v95, v209
  v_max3_f32 v209, v96, v97, v209
  v_max3_f32 v209, v98, v99, v209
  v_max3_f32 v209, v100, v101, v209
  v_max3_f32 v209, v102, v103, v209
  s_add_u32 s35, s35, 1
  s_cmp_lt_u32 s35, 16
  s_cbranch_scc1 standalone__softmax_full_mha__prompt_kernel_pre
  v_mov_b32 v2, v206
  s_nop 1
  v_permlane32_swap_b32 v206, v2
  s_nop 1
  v_max_f32 v206, v206, v2
  v_mov_b32 v2, v207
  s_nop 1
  v_permlane32_swap_b32 v207, v2
  s_nop 1
  v_max_f32 v207, v207, v2
  v_mov_b32 v2, v208
  s_nop 1
  v_permlane32_swap_b32 v208, v2
  s_nop 1
  v_max_f32 v208, v208, v2
  v_mov_b32 v2, v209
  s_nop 1
  v_permlane32_swap_b32 v209, v2
  s_nop 1
  v_max_f32 v209, v209, v2
  s_lshl_b32 s36, s12, 2
  s_add_u32 s37, s36, s19
  s_lshl_b32 s37, s37, 10
  s_add_u32 s37, s37, 59392
  s_lshl_b32 s36, s36, 10
  s_add_u32 s36, s36, 59392
  v_lshrrev_b32 v3, 2, v1
  v_add_u32 v2, s37, v3
  v_add_u32 v3, s36, v3
  s_add_u32 s36, s19, 1
  s_and_b32 s36, s36, 3
  s_lshl_b32 s36, s36, 8
  v_add_u32 v88, s36, v2
  v_add_u32 v92, s36, v3
  s_add_u32 s36, s19, 2
  s_and_b32 s36, s36, 3
  s_lshl_b32 s36, s36, 8
  v_add_u32 v89, s36, v2
  v_add_u32 v93, s36, v3
  s_add_u32 s36, s19, 3
  s_and_b32 s36, s36, 3
  s_lshl_b32 s36, s36, 8
  v_add_u32 v90, s36, v2
  v_add_u32 v94, s36, v3
  s_add_u32 s36, s19, 4
  s_and_b32 s36, s36, 3
  s_lshl_b32 s36, s36, 8
  v_add_u32 v91, s36, v2
  v_add_u32 v95, s36, v3
  ds_write_b32 v88, v206
  ds_write_b32 v89, v207
  ds_write_b32 v90, v208
  ds_write_b32 v91, v209
  s_waitcnt lgkmcnt(0)
  s_barrier
  ds_read_b32 v72, v92 offset:0
  ds_read_b32 v73, v93 offset:0
  ds_read_b32 v74, v94 offset:0
  ds_read_b32 v75, v95 offset:0
  ds_read_b32 v76, v92 offset:1024
  ds_read_b32 v77, v93 offset:1024
  ds_read_b32 v78, v94 offset:1024
  ds_read_b32 v79, v95 offset:1024
  ds_read_b32 v80, v92 offset:2048
  ds_read_b32 v81, v93 offset:2048
  ds_read_b32 v82, v94 offset:2048
  ds_read_b32 v83, v95 offset:2048
  ds_read_b32 v84, v92 offset:3072
  ds_read_b32 v85, v93 offset:3072
  ds_read_b32 v86, v94 offset:3072
  ds_read_b32 v87, v95 offset:3072
  s_waitcnt lgkmcnt(0)
  v_max3_f32 v206, v72, v76, v80
  v_max_f32 v206, v206, v84
  v_max3_f32 v207, v73, v77, v81
  v_max_f32 v207, v207, v85
  v_max3_f32 v208, v74, v78, v82
  v_max_f32 v208, v208, v86
  v_max3_f32 v209, v75, v79, v83
  v_max_f32 v209, v209, v87
  s_barrier
  s_mov_b64 s[54:55], 0
  s_mov_b32 s39, 16
  v_mov_b32 v112, 0
  v_mov_b32 v113, 0
  v_mov_b32 v114, 0
  v_mov_b32 v115, 0
  v_mov_b32 v116, 0
  v_mov_b32 v117, 0
  v_mov_b32 v118, 0
  v_mov_b32 v119, 0
  v_mov_b32 v68, 0
  v_mov_b32 v69, 0
  v_mov_b32 v70, 0
  v_mov_b32 v71, 0
  s_cmp_eq_u32 s39, 0
  s_cbranch_scc1 standalone__softmax_full_mha__prompt_kernel_rdy7_oob
  s_andn2_b64 s[56:57], s[62:63], s[54:55]
  s_cbranch_scc1 standalone__softmax_full_mha__prompt_kernel_rdy7_ok
  s_mov_b32 s37, 0
standalone__softmax_full_mha__prompt_kernel_rdy7_p:
  buffer_load_dword v217, v216, s[28:31], s60 offen sc1
  s_waitcnt vmcnt(0)
  v_cmp_eq_u32 vcc, s48, v217
  s_add_u32 s37, s37, 1
  s_lshr_b64 s[62:63], vcc, s61
  s_and_b32 s62, s62, 0x11111111
  s_and_b32 s63, s63, 0x11111111
  s_cmp_gt_u32 s37, 200000
  s_cselect_b32 s36, 0x11111111, 0
  s_or_b32 s62, s62, s36
  s_or_b32 s63, s63, s36
  s_andn2_b64 s[56:57], s[62:63], s[54:55]
  s_cbranch_scc1 standalone__softmax_full_mha__prompt_kernel_rdy7_ok
  s_sleep 1
  s_branch standalone__softmax_full_mha__prompt_kernel_rdy7_p
standalone__softmax_full_mha__prompt_kernel_rdy7_ok:
  s_ff1_i32_b64 s36, s[56:57]
  s_bitset1_b64 s[54:55], s36
  s_lshl_b32 s38, s36, 12
  s_add_u32 s38, s38, s41
  s_sub_u32 s39, s39, 1
  s_branch standalone__softmax_full_mha__prompt_kernel_rdy7_e
standalone__softmax_full_mha__prompt_kernel_rdy7_oob:
  s_mov_b32 s38, 0x80000000
standalone__softmax_full_mha__prompt_kernel_rdy7_e:
  buffer_load_dwordx4 v[40:43], v1, s[28:31], s38 offen offset:0 sc1
  buffer_load_dwordx4 v[44:47], v1, s[28:31], s38 offen offset:1024 sc1
  buffer_load_dwordx4 v[56:59], v1, s[28:31], s38 offen offset:2048 sc1
  buffer_load_dwordx4 v[60:63], v1, s[28:31], s38 offen offset:3072 sc1
  s_cmp_ge_u32 s52, s13
  s_cbranch_scc1 standalone__softmax_full_mha__prompt_kernel_wp5_t
  s_mov_b32 m0, s53
  s_add_u32 s53, s53, 8192
  buffer_load_dwordx4 v210, s[20:23], s52 offen lds
  s_branch standalone__softmax_full_mha__prompt_kernel_wp5_e
standalone__softmax_full_mha__prompt_kernel_wp5_t:
  buffer_load_dword v211, v210, s[20:23], s52 offen
standalone__softmax_full_mha__prompt_kernel_wp5_e:
  s_add_u32 s52, s52, 131072
  s_cmp_eq_u32 s39, 0
  s_cbranch_scc1 standalone__softmax_full_mha__prompt_kernel_rdy8_oob
  s_andn2_b64 s[56:57], s[62:63], s[54:55]
  s_cbranch_scc1 standalone__softmax_full_mha__prompt_kernel_rdy8_ok
  s_mov_b32 s37, 0
standalone__softmax_full_mha__prompt_kernel_rdy8_p:
  buffer_load_dword v217, v216, s[28:31], s60 offen sc1
  s_waitcnt vmcnt(0)
  v_cmp_eq_u32 vcc, s48, v217
  s_add_u32 s37, s37, 1
  s_lshr_b64 s[62:63], vcc, s61
  s_and_b32 s62, s62, 0x11111111
  s_and_b32 s63, s63, 0x11111111
  s_cmp_gt_u32 s37, 200000
  s_cselect_b32 s36, 0x11111111, 0
  s_or_b32 s62, s62, s36
  s_or_b32 s63, s63, s36
  s_andn2_b64 s[56:57], s[62:63], s[54:55]
  s_cbranch_scc1 standalone__softmax_full_mha__prompt_kernel_rdy8_ok
  s_sleep 1
  s_branch standalone__softmax_full_mha__prompt_kernel_rdy8_p
standalone__softmax_full_mha__prompt_kernel_rdy8_ok:
  s_ff1_i32_b64 s36, s[56:57]
  s_bitset1_b64 s[54:55], s36
  s_lshl_b32 s38, s36, 12
  s_add_u32 s38, s38, s41
  s_sub_u32 s39, s39, 1
  s_branch standalone__softmax_full_mha__prompt_kernel_rdy8_e
standalone__softmax_full_mha__prompt_kernel_rdy8_oob:
  s_mov_b32 s38, 0x80000000
standalone__softmax_full_mha__prompt_kernel_rdy8_e:
  buffer_load_dwordx4 v[48:51], v1, s[28:31], s38 offen offset:0 sc1
  buffer_load_dwordx4 v[52:55], v1, s[28:31], s38 offen offset:1024 sc1
  buffer_load_dwordx4 v[64:67], v1, s[28:31], s38 offen offset:2048 sc1
  s_waitcnt vmcnt(6)
  v_mfma_f32_32x32x16_bf16 v[72:87], v[40:43], v[8:11], 0
  v_mfma_f32_32x32x16_bf16 v[72:87], v[44:47], v[12:15], v[72:87]
  s_mov_b32 s35, 0
  s_nop 15
standalone__softmax_full_mha__prompt_kernel_slowm_loop:
  v_sub_f32 v72, v72, v206
  v_sub_f32 v73, v73, v206
  v_sub_f32 v74, v74, v206
  v_sub_f32 v75, v75, v206
  v_sub_f32 v76, v76, v206
  v_sub_f32 v77, v77, v206
  v_sub_f32 v78, v78, v206
  v_sub_f32 v79, v79, v206
  v_sub_f32 v80, v80, v206
  v_sub_f32 v81, v81, v206
  v_sub_f32 v82, v82, v206
  v_sub_f32 v83, v83, v206
  v_sub_f32 v84, v84, v206
  v_sub_f32 v85, v85, v206
  v_sub_f32 v86, v86, v206
  v_sub_f32 v87, v87, v206
  v_mfma_f32_32x32x16_bf16 v[88:103], v[40:43], v[16:19], 0
  v_exp_f32 v72, v72
  v_exp_f32 v73, v73
  v_exp_f32 v74, v74
  v_mfma_f32_32x32x16_bf16 v[88:103], v[44:47], v[20:23], v[88:103]
  v_exp_f32 v75, v75
  v_exp_f32 v76, v76
  v_exp_f32 v77, v77
  v_mfma_f32_32x32x16_bf16 v[168:183], v[68:71], v[116:119], v[168:183]
  buffer_load_dwordx4 v[68:71], v1, s[28:31], s38 offen offset:3072 sc1
  v_exp_f32 v78, v78
  v_exp_f32 v79, v79
  v_cvt_pk_bf16_f32 v104, v72, v73
  v_cvt_pk_bf16_f32 v105, v74, v75
  v_smfmac_f32_16x16x64_bf16 v[196:199], v[200:203], v[112:119], v204
  v_cvt_pk_bf16_f32 v106, v76, v77
  v_cvt_pk_bf16_f32 v107, v78, v79
  v_exp_f32 v80, v80
  v_exp_f32 v81, v81
  s_waitcnt vmcnt(6)
  v_mfma_f32_32x32x16_bf16 v[120:135], v[56:59], v[104:107], v[120:135]
  v_exp_f32 v82, v82
  v_exp_f32 v83, v83
  v_exp_f32 v84, v84
  v_exp_f32 v85, v85
  v_exp_f32 v86, v86
  v_exp_f32 v87, v87
  v_cvt_pk_bf16_f32 v108, v80, v81
  v_cvt_pk_bf16_f32 v109, v82, v83
  v_cvt_pk_bf16_f32 v110, v84, v85
  v_cvt_pk_bf16_f32 v111, v86, v87
  v_sub_f32 v88, v88, v207
  v_sub_f32 v89, v89, v207
  v_sub_f32 v90, v90, v207
  v_sub_f32 v91, v91, v207
  v_sub_f32 v92, v92, v207
  v_sub_f32 v93, v93, v207
  v_sub_f32 v94, v94, v207
  v_sub_f32 v95, v95, v207
  v_sub_f32 v96, v96, v207
  v_sub_f32 v97, v97, v207
  v_sub_f32 v98, v98, v207
  v_sub_f32 v99, v99, v207
  v_sub_f32 v100, v100, v207
  v_sub_f32 v101, v101, v207
  v_sub_f32 v102, v102, v207
  v_sub_f32 v103, v103, v207
  v_mfma_f32_32x32x16_bf16 v[72:87], v[40:43], v[24:27], 0
  v_exp_f32 v88, v88
  v_exp_f32 v89, v89
  v_exp_f32 v90, v90
  v_mfma_f32_32x32x16_bf16 v[72:87], v[44:47], v[28:31], v[72:87]
  v_exp_f32 v91, v91
  v_exp_f32 v92, v92
  v_exp_f32 v93, v93
  s_waitcnt vmcnt(5)
  v_mfma_f32_32x32x16_bf16 v[120:135], v[60:63], v[108:111], v[120:135]
  s_cmp_ge_u32 s52, s13
  s_cbranch_scc1 standalone__softmax_full_mha__prompt_kernel_wp6_t
  s_mov_b32 m0, s53
  s_add_u32 s53, s53, 8192
  buffer_load_dwordx4 v210, s[20:23], s52 offen lds
  s_branch standalone__softmax_full_mha__prompt_kernel_wp6_e
standalone__softmax_full_mha__prompt_kernel_wp6_t:
  buffer_load_dword v211, v210, s[20:23], s52 offen
standalone__softmax_full_mha__prompt_kernel_wp6_e:
  s_add_u32 s52, s52, 131072
  v_exp_f32 v94, v94
  v_exp_f32 v95, v95
  v_cvt_pk_bf16_f32 v112, v88, v89
  v_cvt_pk_bf16_f32 v113, v90, v91
  v_smfmac_f32_16x16x64_bf16 v[184:187], v[200:203], v[104:111], v204
  v_cvt_pk_bf16_f32 v114, v92, v93
  v_cvt_pk_bf16_f32 v115, v94, v95
  v_exp_f32 v96, v96
  v_exp_f32 v97, v97
  v_mfma_f32_32x32x16_bf16 v[136:151], v[56:59], v[112:115], v[136:151]
  v_exp_f32 v98, v98
  v_exp_f32 v99, v99
  v_exp_f32 v100, v100
  v_exp_f32 v101, v101
  v_exp_f32 v102, v102
  v_exp_f32 v103, v103
  v_cvt_pk_bf16_f32 v116, v96, v97
  v_cvt_pk_bf16_f32 v117, v98, v99
  v_cvt_pk_bf16_f32 v118, v100, v101
  v_cvt_pk_bf16_f32 v119, v102, v103
  v_sub_f32 v72, v72, v208
  v_sub_f32 v73, v73, v208
  v_sub_f32 v74, v74, v208
  v_sub_f32 v75, v75, v208
  v_sub_f32 v76, v76, v208
  v_sub_f32 v77, v77, v208
  v_sub_f32 v78, v78, v208
  v_sub_f32 v79, v79, v208
  v_sub_f32 v80, v80, v208
  v_sub_f32 v81, v81, v208
  v_sub_f32 v82, v82, v208
  v_sub_f32 v83, v83, v208
  v_sub_f32 v84, v84, v208
  v_sub_f32 v85, v85, v208
  v_sub_f32 v86, v86, v208
  v_sub_f32 v87, v87, v208
  v_mfma_f32_32x32x16_bf16 v[88:103], v[40:43], v[32:35], 0
  v_exp_f32 v72, v72
  v_exp_f32 v73, v73
  v_exp_f32 v74, v74
  v_mfma_f32_32x32x16_bf16 v[88:103], v[44:47], v[36:39], v[88:103]
  s_cmp_eq_u32 s39, 0
  s_cbranch_scc1 standalone__softmax_full_mha__prompt_kernel_rdy9_oob
  s_andn2_b64 s[56:57], s[62:63], s[54:55]
  s_cbranch_scc1 standalone__softmax_full_mha__prompt_kernel_rdy9_ok
  s_mov_b32 s37, 0
standalone__softmax_full_mha__prompt_kernel_rdy9_p:
  buffer_load_dword v217, v216, s[28:31], s60 offen sc1
  s_waitcnt vmcnt(0)
  v_cmp_eq_u32 vcc, s48, v217
  s_add_u32 s37, s37, 1
  s_lshr_b64 s[62:63], vcc, s61
  s_and_b32 s62, s62, 0x11111111
  s_and_b32 s63, s63, 0x11111111
  s_cmp_gt_u32 s37, 200000
  s_cselect_b32 s36, 0x11111111, 0
  s_or_b32 s62, s62, s36
  s_or_b32 s63, s63, s36
  s_andn2_b64 s[56:57], s[62:63], s[54:55]
  s_cbranch_scc1 standalone__softmax_full_mha__prompt_kernel_rdy9_ok
  s_sleep 1
  s_branch standalone__softmax_full_mha__prompt_kernel_rdy9_p
standalone__softmax_full_mha__prompt_kernel_rdy9_ok:
  s_ff1_i32_b64 s36, s[56:57]
  s_bitset1_b64 s[54:55], s36
  s_lshl_b32 s38, s36, 12
  s_add_u32 s38, s38, s41
  s_sub_u32 s39, s39, 1
  s_branch standalone__softmax_full_mha__prompt_kernel_rdy9_e
standalone__softmax_full_mha__prompt_kernel_rdy9_oob:
  s_mov_b32 s38, 0x80000000
standalone__softmax_full_mha__prompt_kernel_rdy9_e:
  buffer_load_dwordx4 v[40:43], v1, s[28:31], s38 offen offset:0 sc1
  buffer_load_dwordx4 v[44:47], v1, s[28:31], s38 offen offset:1024 sc1
  v_exp_f32 v75, v75
  v_exp_f32 v76, v76
  v_exp_f32 v77, v77
  v_mfma_f32_32x32x16_bf16 v[136:151], v[60:63], v[116:119], v[136:151]
  v_exp_f32 v78, v78
  v_exp_f32 v79, v79
  v_cvt_pk_bf16_f32 v104, v72, v73
  v_cvt_pk_bf16_f32 v105, v74, v75
  v_smfmac_f32_16x16x64_bf16 v[188:191], v[200:203], v[112:119], v204
  v_cvt_pk_bf16_f32 v106, v76, v77
  v_cvt_pk_bf16_f32 v107, v78, v79
  v_exp_f32 v80, v80
  v_exp_f32 v81, v81
  v_mfma_f32_32x32x16_bf16 v[152:167], v[56:59], v[104:107], v[152:167]
  v_exp_f32 v82, v82
  v_exp_f32 v83, v83
  v_exp_f32 v84, v84
  v_exp_f32 v85, v85
  v_exp_f32 v86, v86
  v_exp_f32 v87, v87
  v_cvt_pk_bf16_f32 v108, v80, v81
  v_cvt_pk_bf16_f32 v109, v82, v83
  v_cvt_pk_bf16_f32 v110, v84, v85
  v_cvt_pk_bf16_f32 v111, v86, v87
  v_sub_f32 v88, v88, v209
  v_sub_f32 v89, v89, v209
  v_sub_f32 v90, v90, v209
  v_sub_f32 v91, v91, v209
  v_sub_f32 v92, v92, v209
  v_sub_f32 v93, v93, v209
  v_sub_f32 v94, v94, v209
  v_sub_f32 v95, v95, v209
  v_sub_f32 v96, v96, v209
  v_sub_f32 v97, v97, v209
  v_sub_f32 v98, v98, v209
  v_sub_f32 v99, v99, v209
  v_sub_f32 v100, v100, v209
  v_sub_f32 v101, v101, v209
  v_sub_f32 v102, v102, v209
  v_sub_f32 v103, v103, v209
  s_waitcnt vmcnt(5)
  v_mfma_f32_32x32x16_bf16 v[72:87], v[48:51], v[8:11], 0
  v_exp_f32 v88, v88
  v_exp_f32 v89, v89
  v_exp_f32 v90, v90
  v_mfma_f32_32x32x16_bf16 v[72:87], v[52:55], v[12:15], v[72:87]
  v_exp_f32 v91, v91
  v_exp_f32 v92, v92
  v_exp_f32 v93, v93
  v_mfma_f32_32x32x16_bf16 v[152:167], v[60:63], v[108:111], v[152:167]
  v_exp_f32 v94, v94
  v_exp_f32 v95, v95
  v_cvt_pk_bf16_f32 v112, v88, v89
  v_cvt_pk_bf16_f32 v113, v90, v91
  v_smfmac_f32_16x16x64_bf16 v[192:195], v[200:203], v[104:111], v204
  v_cvt_pk_bf16_f32 v114, v92, v93
  v_cvt_pk_bf16_f32 v115, v94, v95
  v_exp_f32 v96, v96
  v_exp_f32 v97, v97
  v_mfma_f32_32x32x16_bf16 v[168:183], v[56:59], v[112:115], v[168:183]
  buffer_load_dwordx4 v[56:59], v1, s[28:31], s38 offen offset:2048 sc1
  v_exp_f32 v98, v98
  v_exp_f32 v99, v99
  v_exp_f32 v100, v100
  v_exp_f32 v101, v101
  v_exp_f32 v102, v102
  v_exp_f32 v103, v103
  v_cvt_pk_bf16_f32 v116, v96, v97
  v_cvt_pk_bf16_f32 v117, v98, v99
  v_cvt_pk_bf16_f32 v118, v100, v101
  v_cvt_pk_bf16_f32 v119, v102, v103
  v_sub_f32 v72, v72, v206
  v_sub_f32 v73, v73, v206
  v_sub_f32 v74, v74, v206
  v_sub_f32 v75, v75, v206
  v_sub_f32 v76, v76, v206
  v_sub_f32 v77, v77, v206
  v_sub_f32 v78, v78, v206
  v_sub_f32 v79, v79, v206
  v_sub_f32 v80, v80, v206
  v_sub_f32 v81, v81, v206
  v_sub_f32 v82, v82, v206
  v_sub_f32 v83, v83, v206
  v_sub_f32 v84, v84, v206
  v_sub_f32 v85, v85, v206
  v_sub_f32 v86, v86, v206
  v_sub_f32 v87, v87, v206
  v_mfma_f32_32x32x16_bf16 v[88:103], v[48:51], v[16:19], 0
  v_exp_f32 v72, v72
  v_exp_f32 v73, v73
  v_exp_f32 v74, v74
  v_mfma_f32_32x32x16_bf16 v[88:103], v[52:55], v[20:23], v[88:103]
  v_exp_f32 v75, v75
  v_exp_f32 v76, v76
  v_exp_f32 v77, v77
  v_mfma_f32_32x32x16_bf16 v[168:183], v[60:63], v[116:119], v[168:183]
  buffer_load_dwordx4 v[60:63], v1, s[28:31], s38 offen offset:3072 sc1
  v_exp_f32 v78, v78
  v_exp_f32 v79, v79
  v_cvt_pk_bf16_f32 v104, v72, v73
  v_cvt_pk_bf16_f32 v105, v74, v75
  v_smfmac_f32_16x16x64_bf16 v[196:199], v[200:203], v[112:119], v204
  v_cvt_pk_bf16_f32 v106, v76, v77
  v_cvt_pk_bf16_f32 v107, v78, v79
  v_exp_f32 v80, v80
  v_exp_f32 v81, v81
  s_waitcnt vmcnt(6)
  v_mfma_f32_32x32x16_bf16 v[120:135], v[64:67], v[104:107], v[120:135]
  v_exp_f32 v82, v82
  v_exp_f32 v83, v83
  v_exp_f32 v84, v84
  v_exp_f32 v85, v85
  v_exp_f32 v86, v86
  v_exp_f32 v87, v87
  v_cvt_pk_bf16_f32 v108, v80, v81
  v_cvt_pk_bf16_f32 v109, v82, v83
  v_cvt_pk_bf16_f32 v110, v84, v85
  v_cvt_pk_bf16_f32 v111, v86, v87
  v_sub_f32 v88, v88, v207
  v_sub_f32 v89, v89, v207
  v_sub_f32 v90, v90, v207
  v_sub_f32 v91, v91, v207
  v_sub_f32 v92, v92, v207
  v_sub_f32 v93, v93, v207
  v_sub_f32 v94, v94, v207
  v_sub_f32 v95, v95, v207
  v_sub_f32 v96, v96, v207
  v_sub_f32 v97, v97, v207
  v_sub_f32 v98, v98, v207
  v_sub_f32 v99, v99, v207
  v_sub_f32 v100, v100, v207
  v_sub_f32 v101, v101, v207
  v_sub_f32 v102, v102, v207
  v_sub_f32 v103, v103, v207
  v_mfma_f32_32x32x16_bf16 v[72:87], v[48:51], v[24:27], 0
  v_exp_f32 v88, v88
  v_exp_f32 v89, v89
  v_exp_f32 v90, v90
  v_mfma_f32_32x32x16_bf16 v[72:87], v[52:55], v[28:31], v[72:87]
  v_exp_f32 v91, v91
  v_exp_f32 v92, v92
  v_exp_f32 v93, v93
  s_waitcnt vmcnt(5)
  v_mfma_f32_32x32x16_bf16 v[120:135], v[68:71], v[108:111], v[120:135]
  s_cmp_ge_u32 s52, s13
  s_cbranch_scc1 standalone__softmax_full_mha__prompt_kernel_wp7_t
  s_mov_b32 m0, s53
  s_add_u32 s53, s53, 8192
  buffer_load_dwordx4 v210, s[20:23], s52 offen lds
  s_branch standalone__softmax_full_mha__prompt_kernel_wp7_e
standalone__softmax_full_mha__prompt_kernel_wp7_t:
  buffer_load_dword v211, v210, s[20:23], s52 offen
standalone__softmax_full_mha__prompt_kernel_wp7_e:
  s_add_u32 s52, s52, 131072
  v_exp_f32 v94, v94
  v_exp_f32 v95, v95
  v_cvt_pk_bf16_f32 v112, v88, v89
  v_cvt_pk_bf16_f32 v113, v90, v91
  v_smfmac_f32_16x16x64_bf16 v[184:187], v[200:203], v[104:111], v204
  v_cvt_pk_bf16_f32 v114, v92, v93
  v_cvt_pk_bf16_f32 v115, v94, v95
  v_exp_f32 v96, v96
  v_exp_f32 v97, v97
  v_mfma_f32_32x32x16_bf16 v[136:151], v[64:67], v[112:115], v[136:151]
  v_exp_f32 v98, v98
  v_exp_f32 v99, v99
  v_exp_f32 v100, v100
  v_exp_f32 v101, v101
  v_exp_f32 v102, v102
  v_exp_f32 v103, v103
  v_cvt_pk_bf16_f32 v116, v96, v97
  v_cvt_pk_bf16_f32 v117, v98, v99
  v_cvt_pk_bf16_f32 v118, v100, v101
  v_cvt_pk_bf16_f32 v119, v102, v103
  v_sub_f32 v72, v72, v208
  v_sub_f32 v73, v73, v208
  v_sub_f32 v74, v74, v208
  v_sub_f32 v75, v75, v208
  v_sub_f32 v76, v76, v208
  v_sub_f32 v77, v77, v208
  v_sub_f32 v78, v78, v208
  v_sub_f32 v79, v79, v208
  v_sub_f32 v80, v80, v208
  v_sub_f32 v81, v81, v208
  v_sub_f32 v82, v82, v208
  v_sub_f32 v83, v83, v208
  v_sub_f32 v84, v84, v208
  v_sub_f32 v85, v85, v208
  v_sub_f32 v86, v86, v208
  v_sub_f32 v87, v87, v208
  v_mfma_f32_32x32x16_bf16 v[88:103], v[48:51], v[32:35], 0
  v_exp_f32 v72, v72
  v_exp_f32 v73, v73
  v_exp_f32 v74, v74
  v_mfma_f32_32x32x16_bf16 v[88:103], v[52:55], v[36:39], v[88:103]
  s_cmp_eq_u32 s39, 0
  s_cbranch_scc1 standalone__softmax_full_mha__prompt_kernel_rdy10_oob
  s_andn2_b64 s[56:57], s[62:63], s[54:55]
  s_cbranch_scc1 standalone__softmax_full_mha__prompt_kernel_rdy10_ok
  s_mov_b32 s37, 0
standalone__softmax_full_mha__prompt_kernel_rdy10_p:
  buffer_load_dword v217, v216, s[28:31], s60 offen sc1
  s_waitcnt vmcnt(0)
  v_cmp_eq_u32 vcc, s48, v217
  s_add_u32 s37, s37, 1
  s_lshr_b64 s[62:63], vcc, s61
  s_and_b32 s62, s62, 0x11111111
  s_and_b32 s63, s63, 0x11111111
  s_cmp_gt_u32 s37, 200000
  s_cselect_b32 s36, 0x11111111, 0
  s_or_b32 s62, s62, s36
  s_or_b32 s63, s63, s36
  s_andn2_b64 s[56:57], s[62:63], s[54:55]
  s_cbranch_scc1 standalone__softmax_full_mha__prompt_kernel_rdy10_ok
  s_sleep 1
  s_branch standalone__softmax_full_mha__prompt_kernel_rdy10_p
standalone__softmax_full_mha__prompt_kernel_rdy10_ok:
  s_ff1_i32_b64 s36, s[56:57]
  s_bitset1_b64 s[54:55], s36
  s_lshl_b32 s38, s36, 12
  s_add_u32 s38, s38, s41
  s_sub_u32 s39, s39, 1
  s_branch standalone__softmax_full_mha__prompt_kernel_rdy10_e
standalone__softmax_full_mha__prompt_kernel_rdy10_oob:
  s_mov_b32 s38, 0x80000000
standalone__softmax_full_mha__prompt_kernel_rdy10_e:
  buffer_load_dwordx4 v[48:51], v1, s[28:31], s38 offen offset:0 sc1
  buffer_load_dwordx4 v[52:55], v1, s[28:31], s38 offen offset:1024 sc1
  v_exp_f32 v75, v75
  v_exp_f32 v76, v76
  v_exp_f32 v77, v77
  v_mfma_f32_32x32x16_bf16 v[136:151], v[68:71], v[116:119], v[136:151]
  v_exp_f32 v78, v78
  v_exp_f32 v79, v79
  v_cvt_pk_bf16_f32 v104, v72, v73
  v_cvt_pk_bf16_f32 v105, v74, v75
  v_smfmac_f32_16x16x64_bf16 v[188:191], v[200:203], v[112:119], v204
  v_cvt_pk_bf16_f32 v106, v76, v77
  v_cvt_pk_bf16_f32 v107, v78, v79
  v_exp_f32 v80, v80
  v_exp_f32 v81, v81
  v_mfma_f32_32x32x16_bf16 v[152:167], v[64:67], v[104:107], v[152:167]
  v_exp_f32 v82, v82
  v_exp_f32 v83, v83
  v_exp_f32 v84, v84
  v_exp_f32 v85, v85
  v_exp_f32 v86, v86
  v_exp_f32 v87, v87
  v_cvt_pk_bf16_f32 v108, v80, v81
  v_cvt_pk_bf16_f32 v109, v82, v83
  v_cvt_pk_bf16_f32 v110, v84, v85
  v_cvt_pk_bf16_f32 v111, v86, v87
  v_sub_f32 v88, v88, v209
  v_sub_f32 v89, v89, v209
  v_sub_f32 v90, v90, v209
  v_sub_f32 v91, v91, v209
  v_sub_f32 v92, v92, v209
  v_sub_f32 v93, v93, v209
  v_sub_f32 v94, v94, v209
  v_sub_f32 v95, v95, v209
  v_sub_f32 v96, v96, v209
  v_sub_f32 v97, v97, v209
  v_sub_f32 v98, v98, v209
  v_sub_f32 v99, v99, v209
  v_sub_f32 v100, v100, v209
  v_sub_f32 v101, v101, v209
  v_sub_f32 v102, v102, v209
  v_sub_f32 v103, v103, v209
  s_waitcnt vmcnt(5)
  v_mfma_f32_32x32x16_bf16 v[72:87], v[40:43], v[8:11], 0
  v_exp_f32 v88, v88
  v_exp_f32 v89, v89
  v_exp_f32 v90, v90
  v_mfma_f32_32x32x16_bf16 v[72:87], v[44:47], v[12:15], v[72:87]
  v_exp_f32 v91, v91
  v_exp_f32 v92, v92
  v_exp_f32 v93, v93
  v_mfma_f32_32x32x16_bf16 v[152:167], v[68:71], v[108:111], v[152:167]
  v_exp_f32 v94, v94
  v_exp_f32 v95, v95
  v_cvt_pk_bf16_f32 v112, v88, v89
  v_cvt_pk_bf16_f32 v113, v90, v91
  v_smfmac_f32_16x16x64_bf16 v[192:195], v[200:203], v[104:111], v204
  v_cvt_pk_bf16_f32 v114, v92, v93
  v_cvt_pk_bf16_f32 v115, v94, v95
  v_exp_f32 v96, v96
  v_exp_f32 v97, v97
  v_mfma_f32_32x32x16_bf16 v[168:183], v[64:67], v[112:115], v[168:183]
  buffer_load_dwordx4 v[64:67], v1, s[28:31], s38 offen offset:2048 sc1
  v_exp_f32 v98, v98
  v_exp_f32 v99, v99
  v_exp_f32 v100, v100
  v_exp_f32 v101, v101
  v_exp_f32 v102, v102
  v_exp_f32 v103, v103
  v_cvt_pk_bf16_f32 v116, v96, v97
  v_cvt_pk_bf16_f32 v117, v98, v99
  v_cvt_pk_bf16_f32 v118, v100, v101
  v_cvt_pk_bf16_f32 v119, v102, v103
  s_add_u32 s35, s35, 2
  s_cmp_lt_u32 s35, 16
  s_cbranch_scc1 standalone__softmax_full_mha__prompt_kernel_slowm_loop
  s_nop 1
  v_mfma_f32_32x32x16_bf16 v[168:183], v[68:71], v[116:119], v[168:183]
  v_smfmac_f32_16x16x64_bf16 v[196:199], v[200:203], v[112:119], v204
  s_nop 15
  v_add_f32 v184, v184, v185
  ds_write_b128 v219, v[120:123] offset:0
  ds_write_b128 v219, v[124:127] offset:1024
  ds_write_b128 v219, v[128:131] offset:2048
  ds_write_b128 v219, v[132:135] offset:3072
  ds_write_b32 v222, v184 offset:4096
  v_add_f32 v188, v188, v189
  ds_write_b128 v220, v[136:139] offset:0
  ds_write_b128 v220, v[140:143] offset:1024
  ds_write_b128 v220, v[144:147] offset:2048
  ds_write_b128 v220, v[148:151] offset:3072
  ds_write_b32 v223, v188 offset:4096
  s_branch standalone__softmax_full_mha__prompt_kernel_fin
standalone__softmax_full_mha__prompt_kernel_end:
  s_endpgm
.section .rodata,"a"
.p2align 6
.amdhsa_kernel standalone__softmax_full_mha__prompt_kernel
  .amdhsa_next_free_vgpr 240
  .amdhsa_next_free_sgpr 64
  .amdhsa_accum_offset 240
  .amdhsa_group_segment_fixed_size 0
  .amdhsa_kernarg_size 48
  .amdhsa_user_sgpr_count 2
  .amdhsa_user_sgpr_kernarg_segment_ptr 1
  .amdhsa_system_sgpr_workgroup_id_x 1
  .amdhsa_float_denorm_mode_32 3
  .amdhsa_float_denorm_mode_16_64 3
.end_amdhsa_kernel
```
